```python
import torch

def _softmax(x, axis=-1):
    return torch.softmax(x, dim=axis)
def _gelu(x):
    return torch.nn.functional.gelu(x, approximate="tanh")
def _silu(x):
    return torch.nn.functional.silu(x)
def _sigmoid(x):
    return torch.sigmoid(x)
def _layernorm(x, axis=-1, eps=1e-5):
    m = x.mean(dim=axis, keepdim=True)
    v = x.var(dim=axis, keepdim=True, unbiased=False)
    return (x - m) / torch.sqrt(v + eps)
def _scatter_add(tgt, idx, src, axis=0):
    return tgt.clone().index_add_(axis, idx, src)
def _segment_sum(src, seg, n):
    out = torch.zeros((n,) + src.shape[1:], dtype=src.dtype)
    return out.index_add_(0, seg, src)
def _pad(x, pw):
    flat = tuple(v for pair in reversed(pw) for v in pair)
    return torch.nn.functional.pad(x, flat)

kernel_name = 'recurrent_scan__grouped_kv_mqa__swiglu_ffn__prompt'

def setup_inputs():

    _w = (lambda a: (lambda t: t.to(torch.bfloat16) if t.is_floating_point() else t)(torch.as_tensor(a)))
    def _A_setup():
        B, S, D, H = 1, 2048, 512, 32
        Dh = D // H
        return {
            "x": _w((lambda *s: torch.randn(*s, dtype=torch.bfloat16) * 0.05)(B, S, D)),
            "wq": _w((lambda *s: torch.randn(*s, dtype=torch.bfloat16) * 0.05)(D, H * Dh)),
            "wk": _w((lambda *s: torch.randn(*s, dtype=torch.bfloat16) * 0.05)(D, Dh)),
            "wv": _w((lambda *s: torch.randn(*s, dtype=torch.bfloat16) * 0.05)(D, Dh)),
            "wo": _w((lambda *s: torch.randn(*s, dtype=torch.bfloat16) * 0.05)(H * Dh, D)),
        }
    _A_in = _A_setup()

    def _B_setup():
        B, S, D, F = 1, 2048, 512, 1792
        return {
            "x": _w((lambda *s: torch.randn(*s, dtype=torch.bfloat16) * 0.05)(B, S, D)),
            "w_gate": _w((lambda *s: torch.randn(*s, dtype=torch.bfloat16) * 0.05)(D, F)),
            "w_up": _w((lambda *s: torch.randn(*s, dtype=torch.bfloat16) * 0.05)(D, F)),
            "w_down": _w((lambda *s: torch.randn(*s, dtype=torch.bfloat16) * 0.05)(F, D)),
        }
    _B_in = _B_setup()

    return {
        "A_x": _A_in["x"],
        "A_wq": _A_in["wq"],
        "A_wk": _A_in["wk"],
        "A_wv": _A_in["wv"],
        "A_wo": _A_in["wo"],
        "B_x": _B_in["x"],
        "B_w_gate": _B_in["w_gate"],
        "B_w_up": _B_in["w_up"],
        "B_w_down": _B_in["w_down"],
    }

def reference(A_x, A_wq, A_wk, A_wv, A_wo, B_x, B_w_gate, B_w_up, B_w_down):
    def _A_ref(x, wq, wk, wv, wo):
        B, S, D = x.shape
        H = 32
        Dh = D // H
        q = (lambda x, *d: x.permute(*d))((x @ wq).reshape(B, S, H, Dh), 0, 2, 1, 3)
        k = x @ wk
        v = x @ wv
        scores = torch.einsum("bhqd,bkd->bhqk", q, k) * (Dh ** -0.5)
        p = _softmax(scores, axis=-1)
        o = torch.einsum("bhqk,bkd->bhqd", p, v)
        return (lambda x, *d: x.permute(*d))(o, 0, 2, 1, 3).reshape(B, S, H * Dh) @ wo

    def _B_ref(x, w_gate, w_up, w_down):
        g = _silu(x @ w_gate)
        u = x @ w_up
        return (g * u) @ w_down

    x = A_x
    xn = _layernorm(x, axis=-1)
    s = _A_ref(xn, A_wq, A_wk, A_wv, A_wo)
    g = _silu(_B_ref(xn, B_w_gate, B_w_up, B_w_down))
    return x + s * g
```

```asm
; @launch grid=(256,1,1) block=(512,1,1) lds=163840
.amdgcn_target "amdgcn-amd-amdhsa--gfx950"
.text
.globl recurrent_scan__grouped_kv_mqa__swiglu_ffn__prompt_kernel
.p2align 8
.type recurrent_scan__grouped_kv_mqa__swiglu_ffn__prompt_kernel,@function
recurrent_scan__grouped_kv_mqa__swiglu_ffn__prompt_kernel:
  s_cmp_ge_u32 s2, 256
  s_cbranch_scc1 recurrent_scan__grouped_kv_mqa__swiglu_ffn__prompt_kernel_exit
  s_getpc_b64 s[92:93]
recurrent_scan__grouped_kv_mqa__swiglu_ffn__prompt_kernel_pc:
  v_lshlrev_b32 v6, 4, v0
  s_bfe_u32 s3, s2, 0x20003
  s_lshl_b32 s3, s3, 13
  v_add_u32 v6, s3, v6
  v_min_u32 v6, (recurrent_scan__grouped_kv_mqa__swiglu_ffn__prompt_kernel_end-recurrent_scan__grouped_kv_mqa__swiglu_ffn__prompt_kernel_pc-16)&0xfffffff0, v6
  global_load_dwordx4 v[252:255], v6, s[92:93]
  s_load_dwordx8 s[36:43], s[0:1], 0
  s_load_dwordx8 s[44:51], s[0:1], 32
  s_load_dwordx8 s[52:59], s[0:1], 64
  v_lshrrev_b32 v5, 6, v0
  v_and_b32 v1, 63, v0
  v_readfirstlane_b32 s4, v5
  s_and_b32 s5, s2, 4
  s_lshl_b32 s5, s5, 1
  s_bfe_u32 s6, s2, 0x30003
  s_or_b32 s5, s5, s6
  s_and_b32 s6, s2, 3
  s_lshl_b32 s6, s6, 2
  s_lshr_b32 s3, s2, 6
  s_or_b32 s6, s6, s3
  v_lshlrev_b32 v2, 4, v1
  v_and_b32 v3, 15, v1
  v_lshrrev_b32 v4, 4, v1
  s_lshr_b32 s7, s4, 2
  s_and_b32 s32, s4, 3
  s_lshl_b32 s79, s4, 11
  s_lshl_b32 s80, s4, 12
  s_lshl_b32 s33, s4, 4
  s_lshl_b32 s34, s5, 7
  s_add_u32 s33, s33, s34
  s_lshl_b32 s33, s33, 10
  v_lshrrev_b32 v5, 3, v1
  v_and_b32 v6, 7, v1
  v_add_u32 v7, 0, v4
  v_xor_b32 v7, v7, v6
  v_lshlrev_b32 v7, 4, v7
  v_add_u32 v8, 0, v5
  v_lshl_add_u32 v7, v8, 10, v7
  v_add_u32 v9, s33, v7
  v_add_u32 v7, 4, v4
  v_xor_b32 v7, v7, v6
  v_lshlrev_b32 v7, 4, v7
  v_add_u32 v8, 8, v5
  v_lshl_add_u32 v7, v8, 10, v7
  v_add_u32 v10, s33, v7
  s_cmp_eq_u32 s4, 7
  s_cbranch_scc1 recurrent_scan__grouped_kv_mqa__swiglu_ffn__prompt_kernel_dq
  s_mul_i32 s34, s6, 224
  s_lshl_b32 s33, s4, 2
  s_add_u32 s33, s33, 0
  s_sub_u32 s72, s33, 14
  s_cmp_ge_u32 s33, 14
  s_cselect_b32 s33, s72, s33
  s_lshl_b32 s33, s33, 6
  v_add_u32 v5, s33, v1
  v_mul_u32_u24 v6, 4682, v5
  v_lshrrev_b32 v6, 16, v6
  v_mul_u32_u24 v7, 14, v6
  v_sub_u32 v5, v5, v7
  v_lshrrev_b32 v7, 1, v6
  v_xor_b32 v7, v7, v6
  v_and_b32 v7, 4, v7
  v_lshl_or_b32 v7, v7, 1, v7
  v_xor_b32 v6, v6, v7
  v_mul_u32_u24 v6, 3584, v6
  v_lshl_add_u32 v5, v5, 4, v6
  v_add_u32 v11, s34, v5
  s_lshl_b32 s33, s4, 2
  s_add_u32 s33, s33, 1
  s_sub_u32 s72, s33, 14
  s_cmp_ge_u32 s33, 14
  s_cselect_b32 s33, s72, s33
  s_lshl_b32 s33, s33, 6
  v_add_u32 v5, s33, v1
  v_mul_u32_u24 v6, 4682, v5
  v_lshrrev_b32 v6, 16, v6
  v_mul_u32_u24 v7, 14, v6
  v_sub_u32 v5, v5, v7
  v_lshrrev_b32 v7, 1, v6
  v_xor_b32 v7, v7, v6
  v_and_b32 v7, 4, v7
  v_lshl_or_b32 v7, v7, 1, v7
  v_xor_b32 v6, v6, v7
  v_mul_u32_u24 v6, 3584, v6
  v_lshl_add_u32 v5, v5, 4, v6
  v_add_u32 v12, s34, v5
  s_lshl_b32 s33, s4, 2
  s_add_u32 s33, s33, 2
  s_sub_u32 s72, s33, 14
  s_cmp_ge_u32 s33, 14
  s_cselect_b32 s33, s72, s33
  s_lshl_b32 s33, s33, 6
  v_add_u32 v5, s33, v1
  v_mul_u32_u24 v6, 4682, v5
  v_lshrrev_b32 v6, 16, v6
  v_mul_u32_u24 v7, 14, v6
  v_sub_u32 v5, v5, v7
  v_lshrrev_b32 v7, 1, v6
  v_xor_b32 v7, v7, v6
  v_and_b32 v7, 4, v7
  v_lshl_or_b32 v7, v7, 1, v7
  v_xor_b32 v6, v6, v7
  v_mul_u32_u24 v6, 3584, v6
  v_lshl_add_u32 v5, v5, 4, v6
  v_add_u32 v13, s34, v5
  s_lshl_b32 s33, s4, 2
  s_add_u32 s33, s33, 3
  s_sub_u32 s72, s33, 14
  s_cmp_ge_u32 s33, 14
  s_cselect_b32 s33, s72, s33
  s_lshl_b32 s33, s33, 6
  v_add_u32 v5, s33, v1
  v_mul_u32_u24 v6, 4682, v5
  v_lshrrev_b32 v6, 16, v6
  v_mul_u32_u24 v7, 14, v6
  v_sub_u32 v5, v5, v7
  v_lshrrev_b32 v7, 1, v6
  v_xor_b32 v7, v7, v6
  v_and_b32 v7, 4, v7
  v_lshl_or_b32 v7, v7, 1, v7
  v_xor_b32 v6, v6, v7
  v_mul_u32_u24 v6, 3584, v6
  v_lshl_add_u32 v5, v5, 4, v6
  v_add_u32 v14, s34, v5
  s_mov_b32 s70, 229376
  s_branch recurrent_scan__grouped_kv_mqa__swiglu_ffn__prompt_kernel_dq_done
recurrent_scan__grouped_kv_mqa__swiglu_ffn__prompt_kernel_dq:
  v_bfe_u32 v5, v1, 1, 4
  v_lshrrev_b32 v7, 1, v5
  v_xor_b32 v7, v7, v5
  v_and_b32 v7, 4, v7
  v_lshl_or_b32 v7, v7, 1, v7
  v_xor_b32 v5, v5, v7
  v_lshlrev_b32 v5, 10, v5
  v_lshrrev_b32 v6, 5, v1
  v_lshl_add_u32 v5, v6, 5, v5
  v_and_b32 v6, 1, v1
  v_lshl_add_u32 v5, v6, 4, v5
  s_lshl_b32 s34, s6, 6
  v_add_u32 v5, s34, v5
  v_add_u32 v11, 0, v5
  v_add_u32 v12, 16384, v5
  v_add_u32 v13, 32768, v5
  v_add_u32 v14, 49152, v5
  s_mov_b32 s70, 65536
recurrent_scan__grouped_kv_mqa__swiglu_ffn__prompt_kernel_dq_done:
  s_waitcnt lgkmcnt(0)
  s_mov_b32 s16, s36
  s_mov_b32 s17, s37
  s_mov_b32 s18, 0x200000
  s_mov_b32 s19, 0x20000
  s_add_u32 s82, s5, s6
  s_and_b32 s82, s82, 7
  s_xor_b32 s33, s5, s6
  s_and_b32 s33, s33, 8
  s_or_b32 s82, s82, s33
  s_lshr_b32 s33, s82, 1
  s_lshl_b32 s68, s33, 7
  s_mul_i32 s69, s33, s70
  s_cmp_lt_u32 s4, 4
  s_cselect_b32 s20, s48, s50
  s_cselect_b32 s21, s49, s51
  s_cmp_eq_u32 s4, 7
  s_cselect_b32 s20, s38, s20
  s_cselect_b32 s21, s39, s21
  s_mov_b32 s33, 1835008
  s_cselect_b32 s22, 524288, s33
  s_mov_b32 s23, 0x20000
  s_cmp_lt_u32 s4, 3
  s_cselect_b32 s24, s48, s50
  s_cselect_b32 s25, s49, s51
  s_cmp_eq_u32 s4, 7
  s_cselect_b32 s24, s38, s24
  s_cselect_b32 s25, s39, s25
  s_mov_b32 s33, 1835008
  s_cselect_b32 s26, 524288, s33
  s_mov_b32 s27, 0x20000
  s_add_u32 m0, s79, 0
  s_nop 0
  buffer_load_dwordx4 v9, s[16:19], s68 offen  lds
  s_add_u32 m0, s79, 1024
  s_nop 0
  buffer_load_dwordx4 v10, s[16:19], s68 offen  lds
  s_add_u32 m0, s80, 16384
  s_add_u32 s68, s68, 128
  buffer_load_dwordx4 v11, s[20:23], s69 offen  lds
  s_add_u32 m0, s80, 17408
  s_nop 0
  buffer_load_dwordx4 v12, s[20:23], s69 offen  lds
  s_add_u32 m0, s80, 18432
  s_nop 0
  buffer_load_dwordx4 v13, s[24:27], s69 offen  lds
  s_add_u32 m0, s80, 19456
  s_nop 0
  buffer_load_dwordx4 v14, s[24:27], s69 offen  lds
  s_add_u32 s69, s69, s70
  s_cmp_eq_u32 s68, 1024
  s_cselect_b32 s68, 0, s68
  s_cselect_b32 s69, 0, s69
  s_cmp_lt_u32 s6, 8
  s_cselect_b32 s28, s40, s42
  s_cselect_b32 s29, s41, s43
  s_mov_b32 s30, 16384
  s_mov_b32 s31, 0x20000
  v_lshrrev_b32 v5, 1, v1
  s_lshl_b32 s33, s4, 6
  v_add_u32 v5, s33, v5
  v_lshrrev_b32 v7, 1, v5
  v_xor_b32 v7, v7, v5
  v_and_b32 v7, 4, v7
  v_lshl_or_b32 v7, v7, 1, v7
  v_xor_b32 v5, v5, v7
  v_and_b32 v6, 1, v1
  v_lshlrev_b32 v5, 5, v5
  v_lshl_add_u32 v224, v6, 4, v5
  v_add_u32 v225, 1024, v224
  s_lshl_b32 s33, s5, 3
  s_and_b32 s34, s6, 7
  s_add_u32 s33, s33, s34
  s_lshl_b32 s33, s33, 14
  s_lshl_b32 s34, s4, 7
  s_add_u32 s33, s33, s34
  v_lshlrev_b32 v5, 10, v3
  v_lshl_add_u32 v5, v4, 4, v5
  v_add_u32 v226, s33, v5
  s_mov_b32 s8, s58
  s_mov_b32 s9, s59
  s_mov_b32 s10, 0x1600000
  s_mov_b32 s11, 0x20000
  s_mov_b32 s12, s56
  s_mov_b32 s13, s57
  s_mov_b32 s14, 0x100
  s_mov_b32 s15, 0x20000
  s_mov_b32 s94, s54
  s_mov_b32 s95, s55
  s_lshl_b32 s33, s5, 4
  s_add_u32 s72, s33, s6
  s_lshl_b32 s71, s72, 3
  s_add_u32 s71, s71, s4
  s_mov_b32 s64, s44
  s_mov_b32 s65, s45
  s_mov_b32 s66, 524288
  s_mov_b32 s67, 0x20000
  s_cmp_ge_u32 s71, 1792
  s_cbranch_scc1 recurrent_scan__grouped_kv_mqa__swiglu_ffn__prompt_kernel_j_wo
  s_mov_b32 s78, 0
  s_mul_hi_u32 s33, s71, 0x4924925
  s_mul_i32 s34, s33, 56
  s_sub_u32 s34, s71, s34
  s_lshl_b32 s73, s71, 10
  s_add_u32 s73, s73, 12582912
  s_lshr_b32 s35, s33, 1
  s_lshl_b32 s35, s35, 6
  s_and_b32 s33, s33, 1
  s_lshl_b32 s33, s33, 3
  s_add_u32 s35, s35, s33
  s_cmp_ge_u32 s34, 48
  s_cbranch_scc1 recurrent_scan__grouped_kv_mqa__swiglu_ffn__prompt_kernel_j_tail
  s_mul_hi_u32 s33, s34, 0x55555556
  s_mul_i32 s71, s33, 3
  s_sub_u32 s71, s34, s71
  s_mul_i32 s33, s33, 112
  s_lshl_b32 s71, s71, 5
  s_add_u32 s33, s33, s71
  s_add_u32 s71, s33, 16
  s_branch recurrent_scan__grouped_kv_mqa__swiglu_ffn__prompt_kernel_j_wd
recurrent_scan__grouped_kv_mqa__swiglu_ffn__prompt_kernel_j_tail:
  s_sub_u32 s33, s34, 48
  s_mul_i32 s33, s33, 224
  s_add_u32 s33, s33, 96
  s_add_u32 s71, s33, 112
recurrent_scan__grouped_kv_mqa__swiglu_ffn__prompt_kernel_j_wd:
  s_lshl_b32 s33, s33, 10
  s_lshl_b32 s71, s71, 10
  s_add_u32 s75, s33, s35
  s_add_u32 s76, s71, s35
  s_mov_b32 s60, s52
  s_mov_b32 s61, s53
  s_mov_b32 s62, 1835008
  s_mov_b32 s63, 0x20000
  s_branch recurrent_scan__grouped_kv_mqa__swiglu_ffn__prompt_kernel_j_done
recurrent_scan__grouped_kv_mqa__swiglu_ffn__prompt_kernel_j_wo:
  s_mov_b32 s78, 1
  s_sub_u32 s71, s71, 1792
  s_lshl_b32 s73, s71, 10
  s_add_u32 s73, s73, 14680064
  s_lshr_b32 s34, s71, 4
  s_and_b32 s75, s71, 15
  s_lshr_b32 s35, s34, 1
  s_lshl_b32 s35, s35, 6
  s_and_b32 s34, s34, 1
  s_lshl_b32 s34, s34, 3
  s_add_u32 s35, s35, s34
  s_lshl_b32 s75, s75, 15
  s_add_u32 s75, s75, s35
  s_add_u32 s76, s75, 8192
  s_mov_b32 s60, s44
  s_mov_b32 s61, s45
  s_mov_b32 s62, 524288
  s_mov_b32 s63, 0x20000
recurrent_scan__grouped_kv_mqa__swiglu_ffn__prompt_kernel_j_done:
  s_add_u32 s71, s72, 256
  s_lshr_b32 s34, s71, 4
  s_and_b32 s77, s71, 15
  s_lshr_b32 s35, s34, 1
  s_lshl_b32 s35, s35, 6
  s_and_b32 s34, s34, 1
  s_lshl_b32 s34, s34, 3
  s_add_u32 s35, s35, s34
  s_lshl_b32 s77, s77, 15
  s_add_u32 s77, s77, s35
  s_add_u32 s33, s77, 8192
  s_lshl_b32 s74, s71, 10
  s_add_u32 s74, s74, 14680064
  s_lshl_b32 s34, s4, 2
  s_add_u32 s74, s74, s34
  s_bitcmp1_b32 s4, 1
  s_cselect_b32 s77, s33, s77
  s_and_b32 s34, s4, 1
  s_lshl_b32 s34, s34, 11
  s_add_u32 s77, s77, s34
  s_cmp_ge_u32 s4, 4
  s_cselect_b32 s77, 0x7ff00000, s77
  s_cselect_b32 s74, 0x7ff00000, s74
  s_and_b32 s40, s4, 1
  s_lshr_b32 s41, s4, 1
  s_lshl_b32 s42, s5, 1
  s_lshr_b32 s33, s6, 3
  s_add_u32 s42, s42, s33
  s_and_b32 s43, s6, 7
  s_add_u32 s33, s41, 0
  s_and_b32 s33, s33, 3
  s_lshl_b32 s34, s42, 2
  s_add_u32 s33, s33, s34
  s_mul_i32 s33, s33, 56
  s_mul_i32 s34, s41, 14
  s_add_u32 s33, s33, s34
  s_lshl_b32 s33, s33, 10
  s_add_u32 s44, s33, 4194304
  s_add_u32 s33, s41, 1
  s_and_b32 s33, s33, 3
  s_lshl_b32 s34, s42, 2
  s_add_u32 s33, s33, s34
  s_mul_i32 s33, s33, 56
  s_mul_i32 s34, s41, 14
  s_add_u32 s33, s33, s34
  s_lshl_b32 s33, s33, 10
  s_add_u32 s45, s33, 4194304
  s_add_u32 s33, s41, 2
  s_and_b32 s33, s33, 3
  s_lshl_b32 s34, s42, 2
  s_add_u32 s33, s33, s34
  s_mul_i32 s33, s33, 56
  s_mul_i32 s34, s41, 14
  s_add_u32 s33, s33, s34
  s_lshl_b32 s33, s33, 10
  s_add_u32 s46, s33, 4194304
  s_add_u32 s33, s41, 3
  s_and_b32 s33, s33, 3
  s_lshl_b32 s34, s42, 2
  s_add_u32 s33, s33, s34
  s_mul_i32 s33, s33, 56
  s_mul_i32 s34, s41, 14
  s_add_u32 s33, s33, s34
  s_lshl_b32 s33, s33, 10
  s_add_u32 s47, s33, 4194304
  s_lshl_b32 s33, s43, 2
  s_lshl_b32 s34, s40, 1
  s_add_u32 s33, s33, s34
  s_add_u32 s33, s33, 0
  s_mul_i32 s33, s33, 56
  s_mul_i32 s34, s41, 14
  s_add_u32 s33, s33, s34
  s_lshl_b32 s33, s33, 10
  s_add_u32 s48, s33, 12582912
  s_lshl_b32 s33, s43, 2
  s_lshl_b32 s34, s40, 1
  s_add_u32 s33, s33, s34
  s_add_u32 s33, s33, 1
  s_mul_i32 s33, s33, 56
  s_mul_i32 s34, s41, 14
  s_add_u32 s33, s33, s34
  s_lshl_b32 s33, s33, 10
  s_add_u32 s49, s33, 12582912
  v_lshrrev_b32 v5, 1, v3
  v_xor_b32 v6, v4, v5
  v_xor_b32 v7, 4, v6
  v_lshlrev_b32 v8, 7, v3
  v_lshl_add_u32 v6, v6, 4, v8
  v_lshl_add_u32 v7, v7, 4, v8
  s_bitcmp1_b32 s82, 0
  s_cselect_b64 vcc, -1, 0
  v_cndmask_b32 v17, v6, v7, vcc
  v_add_u32 v17, s79, v17
  s_lshl_b32 s33, s7, 13
  s_cmp_eq_u32 s7, 0
  s_cselect_b64 vcc, -1, 0
  v_add_u32 v6, s33, v6
  v_add_u32 v7, s33, v7
  v_cndmask_b32 v15, v7, v6, vcc
  v_cndmask_b32 v16, v6, v7, vcc
  v_lshrrev_b32 v5, 2, v3
  v_and_b32 v6, 1, v4
  v_lshl_add_u32 v5, v6, 2, v5
  v_lshrrev_b32 v6, 1, v4
  v_and_b32 v7, 3, v1
  v_lshlrev_b32 v7, 3, v7
  v_lshl_add_u32 v8, v6, 4, v5
  v_lshl_add_u32 v228, v8, 5, v7
  s_add_u32 s33, s79, 147456
  v_add_u32 v228, s33, v228
  v_mul_u32_u24 v8, 224, v8
  v_add_u32 v8, v8, v7
  s_lshl_b32 s33, s32, 6
  s_add_u32 s33, s33, 16384
  s_mul_i32 s34, s7, 7168
  s_add_u32 s35, s33, s34
  s_add_u32 s33, s33, 7168
  s_sub_u32 s33, s33, s34
  v_add_u32 v19, s35, v8
  v_add_u32 v20, s33, v8
  v_lshlrev_b32 v6, 10, v6
  v_lshl_add_u32 v6, v5, 5, v6
  v_add_u32 v6, v6, v7
  s_lshl_b32 s34, s7, 11
  s_add_u32 s35, s34, 45056
  s_sub_u32 s33, 47104, s34
  v_add_u32 v21, s35, v6
  v_add_u32 v22, s33, v6
  v_and_b32 v5, 3, v1
  v_cmp_eq_u32 s[86:87], 1, v5
  v_cmp_eq_u32 s[88:89], 2, v5
  v_cmp_eq_u32 s[90:91], 3, v5
  v_lshrrev_b32 v6, 2, v3
  v_cmp_eq_u32 s[84:85], v6, v4
  v_mov_b32 v36, 0x3f803f80
  v_mov_b32 v37, 0x3f803f80
  v_mov_b32 v38, 0x3f803f80
  v_mov_b32 v39, 0x3f803f80
  v_mov_b32 v18, 1.0
  v_mov_b32 v64, 0
  v_mov_b32 v65, 0
  v_mov_b32 v66, 0
  v_mov_b32 v67, 0
  v_mov_b32 v68, 0
  v_mov_b32 v69, 0
  v_mov_b32 v70, 0
  v_mov_b32 v71, 0
  v_mov_b32 v72, 0
  v_mov_b32 v73, 0
  v_mov_b32 v74, 0
  v_mov_b32 v75, 0
  v_mov_b32 v76, 0
  v_mov_b32 v77, 0
  v_mov_b32 v78, 0
  v_mov_b32 v79, 0
  v_mov_b32 v80, 0
  v_mov_b32 v81, 0
  v_mov_b32 v82, 0
  v_mov_b32 v83, 0
  v_mov_b32 v84, 0
  v_mov_b32 v85, 0
  v_mov_b32 v86, 0
  v_mov_b32 v87, 0
  v_mov_b32 v88, 0
  v_mov_b32 v89, 0
  v_mov_b32 v90, 0
  v_mov_b32 v91, 0
  v_mov_b32 v92, 0
  v_mov_b32 v93, 0
  v_mov_b32 v94, 0
  v_mov_b32 v95, 0
  v_mov_b32 v96, 0
  v_mov_b32 v97, 0
  v_mov_b32 v98, 0
  v_mov_b32 v99, 0
  v_mov_b32 v100, 0
  v_mov_b32 v101, 0
  v_mov_b32 v102, 0
  v_mov_b32 v103, 0
  v_mov_b32 v104, 0
  v_mov_b32 v105, 0
  v_mov_b32 v106, 0
  v_mov_b32 v107, 0
  v_mov_b32 v108, 0
  v_mov_b32 v109, 0
  v_mov_b32 v110, 0
  v_mov_b32 v111, 0
  v_mov_b32 v112, 0
  v_mov_b32 v113, 0
  v_mov_b32 v114, 0
  v_mov_b32 v115, 0
  v_mov_b32 v116, 0
  v_mov_b32 v117, 0
  v_mov_b32 v118, 0
  v_mov_b32 v119, 0
  v_mov_b32 v120, 0
  v_mov_b32 v121, 0
  v_mov_b32 v122, 0
  v_mov_b32 v123, 0
  v_mov_b32 v124, 0
  v_mov_b32 v125, 0
  v_mov_b32 v126, 0
  v_mov_b32 v127, 0
  s_waitcnt vmcnt(0)
  s_add_u32 m0, s79, 147456
  s_nop 0
  buffer_load_dwordx4 v224, s[28:31], 0 offen lds
  s_add_u32 m0, s79, 148480
  s_nop 0
  buffer_load_dwordx4 v225, s[28:31], 0 offen lds
  buffer_load_dwordx4 v[192:195], v226, s[16:19], 0 offen
  buffer_load_dwordx4 v[196:199], v226, s[16:19], 0 offen offset:64
  s_add_u32 m0, s79, 49152
  s_nop 0
  buffer_load_dwordx4 v9, s[16:19], s68 offen  lds
  s_add_u32 m0, s79, 50176
  s_nop 0
  buffer_load_dwordx4 v10, s[16:19], s68 offen  lds
  s_add_u32 m0, s80, 65536
  s_add_u32 s68, s68, 128
  buffer_load_dwordx4 v11, s[20:23], s69 offen  lds
  s_add_u32 m0, s80, 66560
  s_nop 0
  buffer_load_dwordx4 v12, s[20:23], s69 offen  lds
  s_add_u32 m0, s80, 67584
  s_nop 0
  buffer_load_dwordx4 v13, s[24:27], s69 offen  lds
  s_add_u32 m0, s80, 68608
  s_nop 0
  buffer_load_dwordx4 v14, s[24:27], s69 offen  lds
  s_add_u32 s69, s69, s70
  s_cmp_eq_u32 s68, 1024
  s_cselect_b32 s68, 0, s68
  s_cselect_b32 s69, 0, s69
  s_waitcnt vmcnt(10)
  s_barrier
  s_cmp_eq_u32 s32, 3
  s_cbranch_scc1 recurrent_scan__grouped_kv_mqa__swiglu_ffn__prompt_kernel_mainB
  ds_read_b128 v[128:131], v15 offset:0
  ds_read_b128 v[132:135], v15 offset:2048
  ds_read_b128 v[136:139], v15 offset:4096
  ds_read_b128 v[140:143], v15 offset:6144
  ds_read_b128 v[144:147], v16 offset:0
  ds_read_b128 v[148:151], v16 offset:2048
  ds_read_b128 v[152:155], v16 offset:4096
  ds_read_b128 v[156:159], v16 offset:6144
  ds_read_b64_tr_b16 v[160:161], v19 offset:0
  ds_read_b64_tr_b16 v[162:163], v19 offset:1792
  ds_read_b64_tr_b16 v[164:165], v19 offset:14336
  ds_read_b64_tr_b16 v[166:167], v19 offset:16128
  ds_read_b64_tr_b16 v[168:169], v19 offset:32
  ds_read_b64_tr_b16 v[170:171], v19 offset:1824
  ds_read_b64_tr_b16 v[172:173], v19 offset:14368
  ds_read_b64_tr_b16 v[174:175], v19 offset:16160
  ds_read_b64_tr_b16 v[176:177], v20 offset:0
  ds_read_b64_tr_b16 v[178:179], v20 offset:1792
  ds_read_b64_tr_b16 v[180:181], v20 offset:14336
  ds_read_b64_tr_b16 v[182:183], v20 offset:16128
  ds_read_b64_tr_b16 v[184:185], v20 offset:32
  ds_read_b64_tr_b16 v[186:187], v20 offset:1824
  ds_read_b64_tr_b16 v[188:189], v20 offset:14368
  ds_read_b64_tr_b16 v[190:191], v20 offset:16160
  ds_read_b128 v[232:235], v17
  s_add_u32 m0, s79, 98304
  s_nop 0
  buffer_load_dwordx4 v9, s[16:19], s68 offen  lds
  s_add_u32 m0, s79, 99328
  s_nop 0
  buffer_load_dwordx4 v10, s[16:19], s68 offen  lds
  s_add_u32 m0, s80, 114688
  s_add_u32 s68, s68, 128
  buffer_load_dwordx4 v11, s[20:23], s69 offen  lds
  s_add_u32 m0, s80, 115712
  s_nop 0
  buffer_load_dwordx4 v12, s[20:23], s69 offen  lds
  s_add_u32 m0, s80, 116736
  s_nop 0
  buffer_load_dwordx4 v13, s[24:27], s69 offen  lds
  s_add_u32 m0, s80, 117760
  s_nop 0
  buffer_load_dwordx4 v14, s[24:27], s69 offen  lds
  s_add_u32 s69, s69, s70
  s_cmp_eq_u32 s68, 1024
  s_cselect_b32 s68, 0, s68
  s_cselect_b32 s69, 0, s69
  s_waitcnt lgkmcnt(0)
  v_mfma_f32_16x16x32_bf16 v[48:51], v[36:39], v[160:163], 0
  v_mfma_f32_16x16x32_bf16 v[52:55], v[36:39], v[164:167], 0
  v_mfma_f32_16x16x32_bf16 v[56:59], v[36:39], v[168:171], 0
  v_mfma_f32_16x16x32_bf16 v[60:63], v[36:39], v[172:175], 0
  v_mfma_f32_16x16x32_bf16 v[40:43], v[36:39], v[232:235], 0
  v_mfma_f32_16x16x32_bf16 v[44:47], v[232:235], v[232:235], 0
  v_mfma_f32_16x16x32_bf16 v[64:67], v[160:163], v[128:131], v[64:67]
  v_mfma_f32_16x16x32_bf16 v[64:67], v[176:179], v[144:147], v[64:67]
  v_mfma_f32_16x16x32_bf16 v[68:71], v[160:163], v[132:135], v[68:71]
  v_mfma_f32_16x16x32_bf16 v[68:71], v[176:179], v[148:151], v[68:71]
  v_mfma_f32_16x16x32_bf16 v[72:75], v[160:163], v[136:139], v[72:75]
  v_mfma_f32_16x16x32_bf16 v[72:75], v[176:179], v[152:155], v[72:75]
  v_mfma_f32_16x16x32_bf16 v[76:79], v[160:163], v[140:143], v[76:79]
  v_mfma_f32_16x16x32_bf16 v[76:79], v[176:179], v[156:159], v[76:79]
  v_mfma_f32_16x16x32_bf16 v[80:83], v[164:167], v[128:131], v[80:83]
  v_mfma_f32_16x16x32_bf16 v[80:83], v[180:183], v[144:147], v[80:83]
  s_waitcnt vmcnt(12)
  ds_read_b64_tr_b16 v[200:201], v228 offset:0
  ds_read_b64_tr_b16 v[202:203], v228 offset:256
  ds_read_b64_tr_b16 v[204:205], v228 offset:1024
  ds_read_b64_tr_b16 v[206:207], v228 offset:1280
  s_waitcnt lgkmcnt(0)
  s_cmp_ge_u32 s6, 8
  s_cbranch_scc1 recurrent_scan__grouped_kv_mqa__swiglu_ffn__prompt_kernel_A0_p0v
  v_mfma_f32_16x16x32_bf16 v[208:211], v[200:203], v[192:195], 0
  v_mfma_f32_16x16x32_bf16 v[212:215], v[200:203], v[36:39], 0
  v_mfma_f32_16x16x32_bf16 v[216:219], v[36:39], v[192:195], 0
  v_mfma_f32_16x16x32_bf16 v[220:223], v[192:195], v[192:195], 0
  v_mfma_f32_16x16x32_bf16 v[208:211], v[204:207], v[196:199], v[208:211]
  v_mfma_f32_16x16x32_bf16 v[212:215], v[204:207], v[36:39], v[212:215]
  v_mfma_f32_16x16x32_bf16 v[216:219], v[36:39], v[196:199], v[216:219]
  v_mfma_f32_16x16x32_bf16 v[220:223], v[196:199], v[196:199], v[220:223]
  s_branch recurrent_scan__grouped_kv_mqa__swiglu_ffn__prompt_kernel_A0_p0w
recurrent_scan__grouped_kv_mqa__swiglu_ffn__prompt_kernel_A0_p0v:
  v_mfma_f32_16x16x32_bf16 v[208:211], v[192:195], v[200:203], 0
  v_mfma_f32_16x16x32_bf16 v[212:215], v[192:195], v[36:39], 0
  v_mfma_f32_16x16x32_bf16 v[216:219], v[36:39], v[200:203], 0
  v_mfma_f32_16x16x32_bf16 v[220:223], v[192:195], v[192:195], 0
  v_mfma_f32_16x16x32_bf16 v[208:211], v[196:199], v[204:207], v[208:211]
  v_mfma_f32_16x16x32_bf16 v[212:215], v[196:199], v[36:39], v[212:215]
  v_mfma_f32_16x16x32_bf16 v[216:219], v[36:39], v[204:207], v[216:219]
  v_mfma_f32_16x16x32_bf16 v[220:223], v[196:199], v[196:199], v[220:223]
recurrent_scan__grouped_kv_mqa__swiglu_ffn__prompt_kernel_A0_p0w:
  s_add_u32 s33, s79, 147456
  v_add_u32 v5, s33, v2
  v_lshlrev_b32 v6, 4, v4
  v_add_u32 v6, s33, v6
  v_lshlrev_b32 v7, 2, v3
  v_add_u32 v7, s33, v7
  s_nop 3
  v_cndmask_b32 v8, v220, v221, s[86:87]
  v_cndmask_b32 v8, v8, v222, s[88:89]
  v_cndmask_b32 v8, v8, v223, s[90:91]
  ds_write_b128 v5, v[208:211]
  s_mov_b64 exec, s[84:85]
  ds_write_b32 v7, v8 offset:1152
  s_mov_b32 s33, 0x00010001
  s_mov_b32 exec_lo, s33
  s_mov_b32 exec_hi, s33
  ds_write_b128 v6, v[212:215] offset:1024
  s_mov_b64 exec, 0xffff
  ds_write_b32 v7, v216 offset:1088
  s_mov_b64 exec, -1
  s_waitcnt vmcnt(6) lgkmcnt(0)
  s_barrier
  v_mfma_f32_16x16x32_bf16 v[84:87], v[164:167], v[132:135], v[84:87]
  v_mfma_f32_16x16x32_bf16 v[84:87], v[180:183], v[148:151], v[84:87]
  v_add_u32 v15, 0xc000, v15
  v_add_u32 v16, 0xc000, v16
  v_add_u32 v19, 0xc000, v19
  v_add_u32 v20, 0xc000, v20
  ds_read_b128 v[192:195], v15 offset:0
  v_mfma_f32_16x16x32_bf16 v[88:91], v[164:167], v[136:139], v[88:91]
  v_mfma_f32_16x16x32_bf16 v[88:91], v[180:183], v[152:155], v[88:91]
  ds_read_b128 v[196:199], v15 offset:2048
  ds_read_b128 v[200:203], v15 offset:4096
  ds_read_b128 v[204:207], v15 offset:6144
  s_add_u32 m0, s79, 0
  s_nop 0
  buffer_load_dwordx4 v9, s[16:19], s68 offen  lds
  v_mfma_f32_16x16x32_bf16 v[92:95], v[164:167], v[140:143], v[92:95]
  v_mfma_f32_16x16x32_bf16 v[92:95], v[180:183], v[156:159], v[92:95]
  ds_read_b128 v[208:211], v16 offset:0
  ds_read_b128 v[212:215], v16 offset:2048
  ds_read_b128 v[216:219], v16 offset:4096
  s_add_u32 m0, s79, 1024
  s_nop 0
  buffer_load_dwordx4 v10, s[16:19], s68 offen  lds
  v_mfma_f32_16x16x32_bf16 v[96:99], v[168:171], v[128:131], v[96:99]
  v_mfma_f32_16x16x32_bf16 v[96:99], v[184:187], v[144:147], v[96:99]
  ds_read_b128 v[220:223], v16 offset:6144
  ds_read_b64_tr_b16 v[224:225], v19 offset:0
  ds_read_b64_tr_b16 v[226:227], v19 offset:1792
  v_mfma_f32_16x16x32_bf16 v[100:103], v[168:171], v[132:135], v[100:103]
  v_mfma_f32_16x16x32_bf16 v[100:103], v[184:187], v[148:151], v[100:103]
  ds_read_b64_tr_b16 v[228:229], v19 offset:14336
  ds_read_b64_tr_b16 v[230:231], v19 offset:16128
  ds_read_b64_tr_b16 v[232:233], v19 offset:32
  s_add_u32 m0, s80, 16384
  s_add_u32 s68, s68, 128
  buffer_load_dwordx4 v11, s[20:23], s69 offen  lds
  v_mfma_f32_16x16x32_bf16 v[104:107], v[168:171], v[136:139], v[104:107]
  v_mfma_f32_16x16x32_bf16 v[104:107], v[184:187], v[152:155], v[104:107]
  ds_read_b64_tr_b16 v[234:235], v19 offset:1824
  ds_read_b64_tr_b16 v[236:237], v19 offset:14368
  ds_read_b64_tr_b16 v[238:239], v19 offset:16160
  s_add_u32 m0, s80, 17408
  s_nop 0
  buffer_load_dwordx4 v12, s[20:23], s69 offen  lds
  v_mfma_f32_16x16x32_bf16 v[108:111], v[168:171], v[140:143], v[108:111]
  v_mfma_f32_16x16x32_bf16 v[108:111], v[184:187], v[156:159], v[108:111]
  ds_read_b64_tr_b16 v[240:241], v20 offset:0
  ds_read_b64_tr_b16 v[242:243], v20 offset:1792
  ds_read_b64_tr_b16 v[244:245], v20 offset:14336
  v_mfma_f32_16x16x32_bf16 v[112:115], v[172:175], v[128:131], v[112:115]
  v_mfma_f32_16x16x32_bf16 v[112:115], v[188:191], v[144:147], v[112:115]
  ds_read_b64_tr_b16 v[246:247], v20 offset:16128
  ds_read_b64_tr_b16 v[248:249], v20 offset:32
  ds_read_b64_tr_b16 v[250:251], v20 offset:1824
  s_add_u32 m0, s80, 18432
  s_nop 0
  buffer_load_dwordx4 v13, s[24:27], s69 offen  lds
  v_mfma_f32_16x16x32_bf16 v[116:119], v[172:175], v[132:135], v[116:119]
  v_mfma_f32_16x16x32_bf16 v[116:119], v[188:191], v[148:151], v[116:119]
  ds_read_b64_tr_b16 v[252:253], v20 offset:14368
  ds_read_b64_tr_b16 v[254:255], v20 offset:16160
  s_add_u32 m0, s80, 19456
  s_nop 0
  buffer_load_dwordx4 v14, s[24:27], s69 offen  lds
  s_add_u32 s69, s69, s70
  s_cmp_eq_u32 s68, 1024
  s_cselect_b32 s68, 0, s68
  s_cselect_b32 s69, 0, s69
  v_mfma_f32_16x16x32_bf16 v[120:123], v[172:175], v[136:139], v[120:123]
  v_mfma_f32_16x16x32_bf16 v[120:123], v[188:191], v[152:155], v[120:123]
  v_mfma_f32_16x16x32_bf16 v[124:127], v[172:175], v[140:143], v[124:127]
  v_mfma_f32_16x16x32_bf16 v[124:127], v[188:191], v[156:159], v[124:127]
  v_mov_b32 v49, v52
  v_mov_b32 v50, v56
  v_mov_b32 v51, v60
  s_lshl_b32 s33, s6, 4
  s_add_u32 s33, s33, s82
  s_lshl_b32 s33, s33, 2
  s_add_u32 s33, s33, s32
  s_lshl_b32 s33, s33, 8
  s_add_u32 s33, s33, 20971520
  s_and_b32 s34, s82, 1
  s_cmp_eq_u32 s34, s7
  s_cselect_b32 s33, s33, 0x7ff00000
  v_mov_b32 v6, 0x7ff00000
  v_cmp_gt_u32 vcc, 16, v1
  v_cndmask_b32 v8, v44, v45, s[86:87]
  v_cndmask_b32 v8, v8, v46, s[88:89]
  v_cndmask_b32 v5, v6, v2, vcc
  v_cndmask_b32 v41, v8, v47, s[90:91]
  buffer_store_dwordx4 v[48:51], v5, s[8:11], s33 offen sc1
  s_lshl_b32 s33, s5, 4
  s_add_u32 s33, s33, s82
  s_lshl_b32 s33, s33, 3
  s_add_u32 s33, s33, s4
  s_lshl_b32 s33, s33, 7
  s_add_u32 s33, s33, 22020096
  v_lshlrev_b32 v7, 3, v3
  v_cndmask_b32 v7, v6, v7, s[84:85]
  s_nop 0
  buffer_store_dwordx2 v[40:41], v7, s[8:11], s33 offen sc1
  v_bfe_u32 v5, v1, 4, 1
  v_lshlrev_b32 v5, 14, v5
  v_lshrrev_b32 v6, 5, v1
  v_lshl_add_u32 v5, v6, 8, v5
  v_and_b32 v6, 15, v1
  v_lshl_add_u32 v5, v6, 4, v5
  s_lshl_b32 s33, s5, 3
  s_lshl_b32 s34, s32, 1
  s_add_u32 s33, s33, s34
  s_lshl_b32 s33, s33, 4
  s_add_u32 s33, s33, s6
  s_lshl_b32 s33, s33, 10
  s_lshl_b32 s34, s7, 9
  s_add_u32 s33, s33, s34
  s_add_u32 s33, s33, 15728640
  v_mov_b32 v52, -1
  v_mov_b32 v53, -1
  v_mov_b32 v54, -1
  v_mov_b32 v55, -1
  buffer_store_dwordx4 v[52:55], v5, s[8:11], s33 offen sc1
  s_cmp_eq_u32 s4, 1
  s_cbranch_scc0 recurrent_scan__grouped_kv_mqa__swiglu_ffn__prompt_kernel_A0s_skip
  v_add_u32 v5, 147456, v2
  v_lshlrev_b32 v6, 4, v4
  v_add_u32 v6, 147456, v6
  v_lshlrev_b32 v7, 2, v3
  v_add_u32 v7, 147456, v7
  s_cmp_ge_u32 s6, 8
  s_cbranch_scc1 recurrent_scan__grouped_kv_mqa__swiglu_ffn__prompt_kernel_A0s_v
  ds_read_b128 v[128:131], v5 offset:0
  ds_read_b128 v[132:135], v6 offset:1024
  ds_read_b32 v136, v7 offset:1152
  ds_read_b32 v140, v7 offset:1088
  ds_read_b128 v[142:145], v5 offset:2048
  ds_read_b128 v[146:149], v6 offset:3072
  ds_read_b32 v150, v7 offset:3200
  ds_read_b32 v154, v7 offset:3136
  ds_read_b128 v[156:159], v5 offset:4096
  ds_read_b128 v[160:163], v6 offset:5120
  ds_read_b32 v164, v7 offset:5248
  ds_read_b32 v168, v7 offset:5184
  ds_read_b128 v[170:173], v5 offset:6144
  ds_read_b128 v[174:177], v6 offset:7168
  ds_read_b32 v178, v7 offset:7296
  ds_read_b32 v182, v7 offset:7232
  s_branch recurrent_scan__grouped_kv_mqa__swiglu_ffn__prompt_kernel_A0s_r
recurrent_scan__grouped_kv_mqa__swiglu_ffn__prompt_kernel_A0s_v:
  ds_read_b128 v[128:131], v5 offset:0
  ds_read_b128 v[132:135], v6 offset:1024
  ds_read_b128 v[136:139], v6 offset:1152
  ds_read_b32 v140, v7 offset:1088
  ds_read_b128 v[142:145], v5 offset:2048
  ds_read_b128 v[146:149], v6 offset:3072
  ds_read_b128 v[150:153], v6 offset:3200
  ds_read_b32 v154, v7 offset:3136
  ds_read_b128 v[156:159], v5 offset:4096
  ds_read_b128 v[160:163], v6 offset:5120
  ds_read_b128 v[164:167], v6 offset:5248
  ds_read_b32 v168, v7 offset:5184
  ds_read_b128 v[170:173], v5 offset:6144
  ds_read_b128 v[174:177], v6 offset:7168
  ds_read_b128 v[178:181], v6 offset:7296
  ds_read_b32 v182, v7 offset:7232
recurrent_scan__grouped_kv_mqa__swiglu_ffn__prompt_kernel_A0s_r:
  s_waitcnt lgkmcnt(0)
  v_mov_b32 v24, v128
  v_mov_b32 v25, v129
  v_mov_b32 v26, v130
  v_mov_b32 v27, v131
  v_mov_b32 v28, v132
  v_mov_b32 v29, v133
  v_mov_b32 v30, v134
  v_mov_b32 v31, v135
  v_mov_b32 v32, v136
  v_mov_b32 v33, v137
  v_mov_b32 v34, v138
  v_mov_b32 v35, v139
  v_mov_b32 v23, v140
  v_pk_add_f32 v[24:25], v[24:25], v[142:143]
  v_pk_add_f32 v[26:27], v[26:27], v[144:145]
  v_pk_add_f32 v[28:29], v[28:29], v[146:147]
  v_pk_add_f32 v[30:31], v[30:31], v[148:149]
  v_pk_add_f32 v[32:33], v[32:33], v[150:151]
  v_pk_add_f32 v[34:35], v[34:35], v[152:153]
  v_add_f32 v23, v23, v154
  v_pk_add_f32 v[24:25], v[24:25], v[156:157]
  v_pk_add_f32 v[26:27], v[26:27], v[158:159]
  v_pk_add_f32 v[28:29], v[28:29], v[160:161]
  v_pk_add_f32 v[30:31], v[30:31], v[162:163]
  v_pk_add_f32 v[32:33], v[32:33], v[164:165]
  v_pk_add_f32 v[34:35], v[34:35], v[166:167]
  v_add_f32 v23, v23, v168
  v_pk_add_f32 v[24:25], v[24:25], v[170:171]
  v_pk_add_f32 v[26:27], v[26:27], v[172:173]
  v_pk_add_f32 v[28:29], v[28:29], v[174:175]
  v_pk_add_f32 v[30:31], v[30:31], v[176:177]
  v_pk_add_f32 v[32:33], v[32:33], v[178:179]
  v_pk_add_f32 v[34:35], v[34:35], v[180:181]
  v_add_f32 v23, v23, v182
recurrent_scan__grouped_kv_mqa__swiglu_ffn__prompt_kernel_A0s_skip:
  s_waitcnt vmcnt(9) lgkmcnt(0)
  s_barrier
  v_mfma_f32_16x16x32_bf16 v[64:67], v[224:227], v[192:195], v[64:67]
  v_mfma_f32_16x16x32_bf16 v[64:67], v[240:243], v[208:211], v[64:67]
  v_add_u32 v15, 0xc000, v15
  v_add_u32 v16, 0xc000, v16
  v_add_u32 v19, 0xc000, v19
  v_add_u32 v20, 0xc000, v20
  ds_read_b128 v[128:131], v15 offset:0
  v_mfma_f32_16x16x32_bf16 v[68:71], v[224:227], v[196:199], v[68:71]
  v_mfma_f32_16x16x32_bf16 v[68:71], v[240:243], v[212:215], v[68:71]
  ds_read_b128 v[132:135], v15 offset:2048
  ds_read_b128 v[136:139], v15 offset:4096
  s_add_u32 m0, s79, 49152
  s_nop 0
  buffer_load_dwordx4 v9, s[16:19], s68 offen  lds
  v_mfma_f32_16x16x32_bf16 v[72:75], v[224:227], v[200:203], v[72:75]
  v_mfma_f32_16x16x32_bf16 v[72:75], v[240:243], v[216:219], v[72:75]
  ds_read_b128 v[140:143], v15 offset:6144
  ds_read_b128 v[144:147], v16 offset:0
  v_mfma_f32_16x16x32_bf16 v[76:79], v[224:227], v[204:207], v[76:79]
  v_mfma_f32_16x16x32_bf16 v[76:79], v[240:243], v[220:223], v[76:79]
  ds_read_b128 v[148:151], v16 offset:2048
  ds_read_b128 v[152:155], v16 offset:4096
  s_add_u32 m0, s79, 50176
  s_nop 0
  buffer_load_dwordx4 v10, s[16:19], s68 offen  lds
  v_mfma_f32_16x16x32_bf16 v[80:83], v[228:231], v[192:195], v[80:83]
  v_mfma_f32_16x16x32_bf16 v[80:83], v[244:247], v[208:211], v[80:83]
  ds_read_b128 v[156:159], v16 offset:6144
  ds_read_b64_tr_b16 v[160:161], v19 offset:0
  v_mfma_f32_16x16x32_bf16 v[84:87], v[228:231], v[196:199], v[84:87]
  v_mfma_f32_16x16x32_bf16 v[84:87], v[244:247], v[212:215], v[84:87]
  ds_read_b64_tr_b16 v[162:163], v19 offset:1792
  ds_read_b64_tr_b16 v[164:165], v19 offset:14336
  s_add_u32 m0, s80, 65536
  s_add_u32 s68, s68, 128
  buffer_load_dwordx4 v11, s[20:23], s69 offen  lds
  v_mfma_f32_16x16x32_bf16 v[88:91], v[228:231], v[200:203], v[88:91]
  v_mfma_f32_16x16x32_bf16 v[88:91], v[244:247], v[216:219], v[88:91]
  ds_read_b64_tr_b16 v[166:167], v19 offset:16128
  ds_read_b64_tr_b16 v[168:169], v19 offset:32
  v_mfma_f32_16x16x32_bf16 v[92:95], v[228:231], v[204:207], v[92:95]
  v_mfma_f32_16x16x32_bf16 v[92:95], v[244:247], v[220:223], v[92:95]
  ds_read_b64_tr_b16 v[170:171], v19 offset:1824
  ds_read_b64_tr_b16 v[172:173], v19 offset:14368
  v_mfma_f32_16x16x32_bf16 v[96:99], v[232:235], v[192:195], v[96:99]
  v_mfma_f32_16x16x32_bf16 v[96:99], v[248:251], v[208:211], v[96:99]
  ds_read_b64_tr_b16 v[174:175], v19 offset:16160
  ds_read_b64_tr_b16 v[176:177], v20 offset:0
  s_add_u32 m0, s80, 66560
  s_nop 0
  buffer_load_dwordx4 v12, s[20:23], s69 offen  lds
  v_mfma_f32_16x16x32_bf16 v[100:103], v[232:235], v[196:199], v[100:103]
  v_mfma_f32_16x16x32_bf16 v[100:103], v[248:251], v[212:215], v[100:103]
  ds_read_b64_tr_b16 v[178:179], v20 offset:1792
  ds_read_b64_tr_b16 v[180:181], v20 offset:14336
  v_mfma_f32_16x16x32_bf16 v[104:107], v[232:235], v[200:203], v[104:107]
  v_mfma_f32_16x16x32_bf16 v[104:107], v[248:251], v[216:219], v[104:107]
  ds_read_b64_tr_b16 v[182:183], v20 offset:16128
  ds_read_b64_tr_b16 v[184:185], v20 offset:32
  s_add_u32 m0, s80, 67584
  s_nop 0
  buffer_load_dwordx4 v13, s[24:27], s69 offen  lds
  v_mfma_f32_16x16x32_bf16 v[108:111], v[232:235], v[204:207], v[108:111]
  v_mfma_f32_16x16x32_bf16 v[108:111], v[248:251], v[220:223], v[108:111]
  ds_read_b64_tr_b16 v[186:187], v20 offset:1824
  ds_read_b64_tr_b16 v[188:189], v20 offset:14368
  v_mfma_f32_16x16x32_bf16 v[112:115], v[236:239], v[192:195], v[112:115]
  v_mfma_f32_16x16x32_bf16 v[112:115], v[252:255], v[208:211], v[112:115]
  ds_read_b64_tr_b16 v[190:191], v20 offset:16160
  s_add_u32 m0, s80, 68608
  s_nop 0
  buffer_load_dwordx4 v14, s[24:27], s69 offen  lds
  s_add_u32 s69, s69, s70
  s_cmp_eq_u32 s68, 1024
  s_cselect_b32 s68, 0, s68
  s_cselect_b32 s69, 0, s69
  v_mfma_f32_16x16x32_bf16 v[116:119], v[236:239], v[196:199], v[116:119]
  v_mfma_f32_16x16x32_bf16 v[116:119], v[252:255], v[212:215], v[116:119]
  v_mfma_f32_16x16x32_bf16 v[120:123], v[236:239], v[200:203], v[120:123]
  v_mfma_f32_16x16x32_bf16 v[120:123], v[252:255], v[216:219], v[120:123]
  v_mfma_f32_16x16x32_bf16 v[124:127], v[236:239], v[204:207], v[124:127]
  v_mfma_f32_16x16x32_bf16 v[124:127], v[252:255], v[220:223], v[124:127]
  s_cmp_eq_u32 s4, 1
  s_cbranch_scc0 recurrent_scan__grouped_kv_mqa__swiglu_ffn__prompt_kernel_A1s_skip
  v_add_u32 v5, 147456, v2
  v_lshlrev_b32 v6, 4, v4
  v_add_u32 v6, 147456, v6
  v_lshlrev_b32 v7, 2, v3
  v_add_u32 v7, 147456, v7
  s_cmp_ge_u32 s6, 8
  s_cbranch_scc1 recurrent_scan__grouped_kv_mqa__swiglu_ffn__prompt_kernel_A1s_v
  ds_read_b128 v[192:195], v5 offset:8192
  ds_read_b128 v[196:199], v6 offset:9216
  ds_read_b32 v200, v7 offset:9344
  ds_read_b32 v204, v7 offset:9280
  ds_read_b128 v[206:209], v5 offset:10240
  ds_read_b128 v[210:213], v6 offset:11264
  ds_read_b32 v214, v7 offset:11392
  ds_read_b32 v218, v7 offset:11328
  ds_read_b128 v[220:223], v5 offset:12288
  ds_read_b128 v[224:227], v6 offset:13312
  ds_read_b32 v228, v7 offset:13440
  ds_read_b32 v232, v7 offset:13376
  ds_read_b128 v[234:237], v5 offset:14336
  ds_read_b128 v[238:241], v6 offset:15360
  ds_read_b32 v242, v7 offset:15488
  ds_read_b32 v246, v7 offset:15424
  s_branch recurrent_scan__grouped_kv_mqa__swiglu_ffn__prompt_kernel_A1s_r
recurrent_scan__grouped_kv_mqa__swiglu_ffn__prompt_kernel_A1s_v:
  ds_read_b128 v[192:195], v5 offset:8192
  ds_read_b128 v[196:199], v6 offset:9216
  ds_read_b128 v[200:203], v6 offset:9344
  ds_read_b32 v204, v7 offset:9280
  ds_read_b128 v[206:209], v5 offset:10240
  ds_read_b128 v[210:213], v6 offset:11264
  ds_read_b128 v[214:217], v6 offset:11392
  ds_read_b32 v218, v7 offset:11328
  ds_read_b128 v[220:223], v5 offset:12288
  ds_read_b128 v[224:227], v6 offset:13312
  ds_read_b128 v[228:231], v6 offset:13440
  ds_read_b32 v232, v7 offset:13376
  ds_read_b128 v[234:237], v5 offset:14336
  ds_read_b128 v[238:241], v6 offset:15360
  ds_read_b128 v[242:245], v6 offset:15488
  ds_read_b32 v246, v7 offset:15424
recurrent_scan__grouped_kv_mqa__swiglu_ffn__prompt_kernel_A1s_r:
  s_waitcnt lgkmcnt(0)
  v_pk_add_f32 v[24:25], v[24:25], v[192:193]
  v_pk_add_f32 v[26:27], v[26:27], v[194:195]
  v_pk_add_f32 v[28:29], v[28:29], v[196:197]
  v_pk_add_f32 v[30:31], v[30:31], v[198:199]
  v_pk_add_f32 v[32:33], v[32:33], v[200:201]
  v_pk_add_f32 v[34:35], v[34:35], v[202:203]
  v_add_f32 v23, v23, v204
  v_pk_add_f32 v[24:25], v[24:25], v[206:207]
  v_pk_add_f32 v[26:27], v[26:27], v[208:209]
  v_pk_add_f32 v[28:29], v[28:29], v[210:211]
  v_pk_add_f32 v[30:31], v[30:31], v[212:213]
  v_pk_add_f32 v[32:33], v[32:33], v[214:215]
  v_pk_add_f32 v[34:35], v[34:35], v[216:217]
  v_add_f32 v23, v23, v218
  v_pk_add_f32 v[24:25], v[24:25], v[220:221]
  v_pk_add_f32 v[26:27], v[26:27], v[222:223]
  v_pk_add_f32 v[28:29], v[28:29], v[224:225]
  v_pk_add_f32 v[30:31], v[30:31], v[226:227]
  v_pk_add_f32 v[32:33], v[32:33], v[228:229]
  v_pk_add_f32 v[34:35], v[34:35], v[230:231]
  v_add_f32 v23, v23, v232
  v_pk_add_f32 v[24:25], v[24:25], v[234:235]
  v_pk_add_f32 v[26:27], v[26:27], v[236:237]
  v_pk_add_f32 v[28:29], v[28:29], v[238:239]
  v_pk_add_f32 v[30:31], v[30:31], v[240:241]
  v_pk_add_f32 v[32:33], v[32:33], v[242:243]
  v_pk_add_f32 v[34:35], v[34:35], v[244:245]
  v_add_f32 v23, v23, v246
recurrent_scan__grouped_kv_mqa__swiglu_ffn__prompt_kernel_A1s_skip:
  v_mov_b32 v5, 0x7ff00000
  s_cmp_eq_u32 s4, 1
  s_cbranch_scc0 recurrent_scan__grouped_kv_mqa__swiglu_ffn__prompt_kernel_A1f_st
  v_mul_f32 v194, 0x3b000000, v23
  v_fma_f32 v24, -v28, v194, v24
  v_fma_f32 v25, -v29, v194, v25
  v_fma_f32 v26, -v30, v194, v26
  v_fma_f32 v27, -v31, v194, v27
  s_lshl_b32 s33, s5, 3
  s_and_b32 s34, s6, 7
  s_add_u32 s33, s33, s34
  s_cmp_ge_u32 s6, 8
  s_cbranch_scc1 recurrent_scan__grouped_kv_mqa__swiglu_ffn__prompt_kernel_A1f_v
  v_mul_f32 v32, 0x3b000000, v32
  v_fma_f32 v32, -v194, v194, v32
  v_max_f32 v32, 0, v32
  v_add_f32 v32, 0x3727c5ac, v32
  v_rsq_f32 v32, v32
  s_nop 0
  v_mul_f32 v24, v32, v24
  v_mul_f32 v25, v32, v25
  v_mul_f32 v26, v32, v26
  v_mul_f32 v27, v32, v27
  v_lshrrev_b32 v5, 1, v4
  v_lshlrev_b32 v5, 9, v5
  s_lshr_b32 s34, s33, 1
  s_lshl_b32 s34, s34, 10
  s_and_b32 s33, s33, 1
  s_lshl_b32 s33, s33, 8
  s_add_u32 s33, s33, s34
  s_add_u32 s33, s33, 2097152
  s_branch recurrent_scan__grouped_kv_mqa__swiglu_ffn__prompt_kernel_A1f_pack
recurrent_scan__grouped_kv_mqa__swiglu_ffn__prompt_kernel_A1f_v:
  v_mul_f32 v28, 0x3b000000, v28
  v_mul_f32 v32, 0x3b000000, v32
  v_fma_f32 v32, -v28, v28, v32
  v_max_f32 v32, 0, v32
  v_add_f32 v32, 0x3727c5ac, v32
  v_rsq_f32 v32, v32
  v_mul_f32 v29, 0x3b000000, v29
  v_mul_f32 v33, 0x3b000000, v33
  v_fma_f32 v33, -v29, v29, v33
  v_max_f32 v33, 0, v33
  v_add_f32 v33, 0x3727c5ac, v33
  v_rsq_f32 v33, v33
  v_mul_f32 v30, 0x3b000000, v30
  v_mul_f32 v34, 0x3b000000, v34
  v_fma_f32 v34, -v30, v30, v34
  v_max_f32 v34, 0, v34
  v_add_f32 v34, 0x3727c5ac, v34
  v_rsq_f32 v34, v34
  v_mul_f32 v31, 0x3b000000, v31
  v_mul_f32 v35, 0x3b000000, v35
  v_fma_f32 v35, -v31, v31, v35
  v_max_f32 v35, 0, v35
  v_add_f32 v35, 0x3727c5ac, v35
  v_rsq_f32 v35, v35
  s_nop 0
  v_mul_f32 v24, v32, v24
  v_mul_f32 v25, v33, v25
  v_mul_f32 v26, v34, v26
  v_mul_f32 v27, v35, v27
  v_lshrrev_b32 v5, 1, v4
  v_lshlrev_b32 v5, 8, v5
  s_lshl_b32 s33, s33, 9
  s_add_u32 s33, s33, 2162688
recurrent_scan__grouped_kv_mqa__swiglu_ffn__prompt_kernel_A1f_pack:
  v_lshl_add_u32 v5, v3, 4, v5
  v_and_b32 v6, 1, v4
  v_lshl_add_u32 v5, v6, 3, v5
  v_cvt_pk_bf16_f32 v192, v24, v25
  v_cvt_pk_bf16_f32 v193, v26, v27
  v_add_u32 v5, s33, v5
recurrent_scan__grouped_kv_mqa__swiglu_ffn__prompt_kernel_A1f_st:
  buffer_store_dwordx2 v[192:193], v5, s[8:11], 0 offen sc1
  s_waitcnt vmcnt(10) lgkmcnt(0)
  s_barrier
  v_mfma_f32_16x16x32_bf16 v[64:67], v[160:163], v[128:131], v[64:67]
  v_mfma_f32_16x16x32_bf16 v[64:67], v[176:179], v[144:147], v[64:67]
  v_add_u32 v15, 0xfffe8000, v15
  v_add_u32 v16, 0xfffe8000, v16
  v_add_u32 v19, 0xfffe8000, v19
  v_add_u32 v20, 0xfffe8000, v20
  ds_read_b128 v[192:195], v15 offset:0
  v_mfma_f32_16x16x32_bf16 v[68:71], v[160:163], v[132:135], v[68:71]
  v_mfma_f32_16x16x32_bf16 v[68:71], v[176:179], v[148:151], v[68:71]
  ds_read_b128 v[196:199], v15 offset:2048
  ds_read_b128 v[200:203], v15 offset:4096
  s_add_u32 m0, s79, 98304
  s_nop 0
  buffer_load_dwordx4 v9, s[16:19], s68 offen  lds
  v_mfma_f32_16x16x32_bf16 v[72:75], v[160:163], v[136:139], v[72:75]
  v_mfma_f32_16x16x32_bf16 v[72:75], v[176:179], v[152:155], v[72:75]
  ds_read_b128 v[204:207], v15 offset:6144
  ds_read_b128 v[208:211], v16 offset:0
  v_mfma_f32_16x16x32_bf16 v[76:79], v[160:163], v[140:143], v[76:79]
  v_mfma_f32_16x16x32_bf16 v[76:79], v[176:179], v[156:159], v[76:79]
  ds_read_b128 v[212:215], v16 offset:2048
  ds_read_b128 v[216:219], v16 offset:4096
  s_add_u32 m0, s79, 99328
  s_nop 0
  buffer_load_dwordx4 v10, s[16:19], s68 offen  lds
  v_mfma_f32_16x16x32_bf16 v[80:83], v[164:167], v[128:131], v[80:83]
  v_mfma_f32_16x16x32_bf16 v[80:83], v[180:183], v[144:147], v[80:83]
  ds_read_b128 v[220:223], v16 offset:6144
  ds_read_b64_tr_b16 v[224:225], v19 offset:0
  v_mfma_f32_16x16x32_bf16 v[84:87], v[164:167], v[132:135], v[84:87]
  v_mfma_f32_16x16x32_bf16 v[84:87], v[180:183], v[148:151], v[84:87]
  ds_read_b64_tr_b16 v[226:227], v19 offset:1792
  ds_read_b64_tr_b16 v[228:229], v19 offset:14336
  s_add_u32 m0, s80, 114688
  s_add_u32 s68, s68, 128
  buffer_load_dwordx4 v11, s[20:23], s69 offen  lds
  v_mfma_f32_16x16x32_bf16 v[88:91], v[164:167], v[136:139], v[88:91]
  v_mfma_f32_16x16x32_bf16 v[88:91], v[180:183], v[152:155], v[88:91]
  ds_read_b64_tr_b16 v[230:231], v19 offset:16128
  ds_read_b64_tr_b16 v[232:233], v19 offset:32
  v_mfma_f32_16x16x32_bf16 v[92:95], v[164:167], v[140:143], v[92:95]
  v_mfma_f32_16x16x32_bf16 v[92:95], v[180:183], v[156:159], v[92:95]
  ds_read_b64_tr_b16 v[234:235], v19 offset:1824
  ds_read_b64_tr_b16 v[236:237], v19 offset:14368
  v_mfma_f32_16x16x32_bf16 v[96:99], v[168:171], v[128:131], v[96:99]
  v_mfma_f32_16x16x32_bf16 v[96:99], v[184:187], v[144:147], v[96:99]
  ds_read_b64_tr_b16 v[238:239], v19 offset:16160
  ds_read_b64_tr_b16 v[240:241], v20 offset:0
  s_add_u32 m0, s80, 115712
  s_nop 0
  buffer_load_dwordx4 v12, s[20:23], s69 offen  lds
  v_mfma_f32_16x16x32_bf16 v[100:103], v[168:171], v[132:135], v[100:103]
  v_mfma_f32_16x16x32_bf16 v[100:103], v[184:187], v[148:151], v[100:103]
  ds_read_b64_tr_b16 v[242:243], v20 offset:1792
  ds_read_b64_tr_b16 v[244:245], v20 offset:14336
  v_mfma_f32_16x16x32_bf16 v[104:107], v[168:171], v[136:139], v[104:107]
  v_mfma_f32_16x16x32_bf16 v[104:107], v[184:187], v[152:155], v[104:107]
  ds_read_b64_tr_b16 v[246:247], v20 offset:16128
  ds_read_b64_tr_b16 v[248:249], v20 offset:32
  s_add_u32 m0, s80, 116736
  s_nop 0
  buffer_load_dwordx4 v13, s[24:27], s69 offen  lds
  v_mfma_f32_16x16x32_bf16 v[108:111], v[168:171], v[140:143], v[108:111]
  v_mfma_f32_16x16x32_bf16 v[108:111], v[184:187], v[156:159], v[108:111]
  ds_read_b64_tr_b16 v[250:251], v20 offset:1824
  ds_read_b64_tr_b16 v[252:253], v20 offset:14368
  v_mfma_f32_16x16x32_bf16 v[112:115], v[172:175], v[128:131], v[112:115]
  v_mfma_f32_16x16x32_bf16 v[112:115], v[188:191], v[144:147], v[112:115]
  ds_read_b64_tr_b16 v[254:255], v20 offset:16160
  s_add_u32 m0, s80, 117760
  s_nop 0
  buffer_load_dwordx4 v14, s[24:27], s69 offen  lds
  s_add_u32 s69, s69, s70
  s_cmp_eq_u32 s68, 1024
  s_cselect_b32 s68, 0, s68
  s_cselect_b32 s69, 0, s69
  v_mfma_f32_16x16x32_bf16 v[116:119], v[172:175], v[132:135], v[116:119]
  v_mfma_f32_16x16x32_bf16 v[116:119], v[188:191], v[148:151], v[116:119]
  v_mfma_f32_16x16x32_bf16 v[120:123], v[172:175], v[136:139], v[120:123]
  v_mfma_f32_16x16x32_bf16 v[120:123], v[188:191], v[152:155], v[120:123]
  v_mfma_f32_16x16x32_bf16 v[124:127], v[172:175], v[140:143], v[124:127]
  v_mfma_f32_16x16x32_bf16 v[124:127], v[188:191], v[156:159], v[124:127]
  s_waitcnt vmcnt(6) lgkmcnt(0)
  s_barrier
  s_lshl_b32 s33, s5, 4
  s_add_u32 s33, s33, s6
  s_and_b32 s34, s33, 3
  s_lshl_b32 s34, s34, 3
  s_lshl_b32 s34, 1, s34
  s_and_b32 s33, s33, 0xfc
  s_cmp_eq_u32 s4, 0
  s_cselect_b32 s33, s33, 0x7ff00000
  v_mov_b32 v5, s34
  v_mov_b32 v6, s33
  s_mov_b64 exec, 1
  buffer_atomic_or v5, v6, s[12:15], 0 offen sc1
  s_mov_b64 exec, -1
  v_mfma_f32_16x16x32_bf16 v[64:67], v[224:227], v[192:195], v[64:67]
  v_mfma_f32_16x16x32_bf16 v[64:67], v[240:243], v[208:211], v[64:67]
  v_add_u32 v15, 0xc000, v15
  v_add_u32 v16, 0xc000, v16
  v_add_u32 v19, 0xc000, v19
  v_add_u32 v20, 0xc000, v20
  ds_read_b128 v[128:131], v15 offset:0
  v_mfma_f32_16x16x32_bf16 v[68:71], v[224:227], v[196:199], v[68:71]
  v_mfma_f32_16x16x32_bf16 v[68:71], v[240:243], v[212:215], v[68:71]
  ds_read_b128 v[132:135], v15 offset:2048
  ds_read_b128 v[136:139], v15 offset:4096
  s_add_u32 m0, s79, 0
  s_nop 0
  buffer_load_dwordx4 v9, s[16:19], s68 offen  lds
  v_mfma_f32_16x16x32_bf16 v[72:75], v[224:227], v[200:203], v[72:75]
  v_mfma_f32_16x16x32_bf16 v[72:75], v[240:243], v[216:219], v[72:75]
  ds_read_b128 v[140:143], v15 offset:6144
  ds_read_b128 v[144:147], v16 offset:0
  v_mfma_f32_16x16x32_bf16 v[76:79], v[224:227], v[204:207], v[76:79]
  v_mfma_f32_16x16x32_bf16 v[76:79], v[240:243], v[220:223], v[76:79]
  ds_read_b128 v[148:151], v16 offset:2048
  ds_read_b128 v[152:155], v16 offset:4096
  s_add_u32 m0, s79, 1024
  s_nop 0
  buffer_load_dwordx4 v10, s[16:19], s68 offen  lds
  v_mfma_f32_16x16x32_bf16 v[80:83], v[228:231], v[192:195], v[80:83]
  v_mfma_f32_16x16x32_bf16 v[80:83], v[244:247], v[208:211], v[80:83]
  ds_read_b128 v[156:159], v16 offset:6144
  ds_read_b64_tr_b16 v[160:161], v19 offset:0
  v_mfma_f32_16x16x32_bf16 v[84:87], v[228:231], v[196:199], v[84:87]
  v_mfma_f32_16x16x32_bf16 v[84:87], v[244:247], v[212:215], v[84:87]
  ds_read_b64_tr_b16 v[162:163], v19 offset:1792
  ds_read_b64_tr_b16 v[164:165], v19 offset:14336
  s_add_u32 m0, s80, 16384
  s_add_u32 s68, s68, 128
  buffer_load_dwordx4 v11, s[20:23], s69 offen  lds
  v_mfma_f32_16x16x32_bf16 v[88:91], v[228:231], v[200:203], v[88:91]
  v_mfma_f32_16x16x32_bf16 v[88:91], v[244:247], v[216:219], v[88:91]
  ds_read_b64_tr_b16 v[166:167], v19 offset:16128
  ds_read_b64_tr_b16 v[168:169], v19 offset:32
  v_mfma_f32_16x16x32_bf16 v[92:95], v[228:231], v[204:207], v[92:95]
  v_mfma_f32_16x16x32_bf16 v[92:95], v[244:247], v[220:223], v[92:95]
  ds_read_b64_tr_b16 v[170:171], v19 offset:1824
  ds_read_b64_tr_b16 v[172:173], v19 offset:14368
  v_mfma_f32_16x16x32_bf16 v[96:99], v[232:235], v[192:195], v[96:99]
  v_mfma_f32_16x16x32_bf16 v[96:99], v[248:251], v[208:211], v[96:99]
  ds_read_b64_tr_b16 v[174:175], v19 offset:16160
  ds_read_b64_tr_b16 v[176:177], v20 offset:0
  s_add_u32 m0, s80, 17408
  s_nop 0
  buffer_load_dwordx4 v12, s[20:23], s69 offen  lds
  v_mfma_f32_16x16x32_bf16 v[100:103], v[232:235], v[196:199], v[100:103]
  v_mfma_f32_16x16x32_bf16 v[100:103], v[248:251], v[212:215], v[100:103]
  ds_read_b64_tr_b16 v[178:179], v20 offset:1792
  ds_read_b64_tr_b16 v[180:181], v20 offset:14336
  v_mfma_f32_16x16x32_bf16 v[104:107], v[232:235], v[200:203], v[104:107]
  v_mfma_f32_16x16x32_bf16 v[104:107], v[248:251], v[216:219], v[104:107]
  ds_read_b64_tr_b16 v[182:183], v20 offset:16128
  ds_read_b64_tr_b16 v[184:185], v20 offset:32
  s_add_u32 m0, s80, 18432
  s_nop 0
  buffer_load_dwordx4 v13, s[24:27], s69 offen  lds
  v_mfma_f32_16x16x32_bf16 v[108:111], v[232:235], v[204:207], v[108:111]
  v_mfma_f32_16x16x32_bf16 v[108:111], v[248:251], v[220:223], v[108:111]
  ds_read_b64_tr_b16 v[186:187], v20 offset:1824
  ds_read_b64_tr_b16 v[188:189], v20 offset:14368
  v_mfma_f32_16x16x32_bf16 v[112:115], v[236:239], v[192:195], v[112:115]
  v_mfma_f32_16x16x32_bf16 v[112:115], v[252:255], v[208:211], v[112:115]
  ds_read_b64_tr_b16 v[190:191], v20 offset:16160
  s_add_u32 m0, s80, 19456
  s_nop 0
  buffer_load_dwordx4 v14, s[24:27], s69 offen  lds
  s_add_u32 s69, s69, s70
  s_cmp_eq_u32 s68, 1024
  s_cselect_b32 s68, 0, s68
  s_cselect_b32 s69, 0, s69
  v_mfma_f32_16x16x32_bf16 v[116:119], v[236:239], v[196:199], v[116:119]
  v_mfma_f32_16x16x32_bf16 v[116:119], v[252:255], v[212:215], v[116:119]
  v_mfma_f32_16x16x32_bf16 v[120:123], v[236:239], v[200:203], v[120:123]
  v_mfma_f32_16x16x32_bf16 v[120:123], v[252:255], v[216:219], v[120:123]
  v_mfma_f32_16x16x32_bf16 v[124:127], v[236:239], v[204:207], v[124:127]
  v_mfma_f32_16x16x32_bf16 v[124:127], v[252:255], v[220:223], v[124:127]
  s_waitcnt vmcnt(7) lgkmcnt(0)
  s_barrier
  v_mfma_f32_16x16x32_bf16 v[64:67], v[160:163], v[128:131], v[64:67]
  v_mfma_f32_16x16x32_bf16 v[64:67], v[176:179], v[144:147], v[64:67]
  v_add_u32 v15, 0xc000, v15
  v_add_u32 v16, 0xc000, v16
  v_add_u32 v19, 0xc000, v19
  v_add_u32 v20, 0xc000, v20
  ds_read_b128 v[192:195], v15 offset:0
  v_mfma_f32_16x16x32_bf16 v[68:71], v[160:163], v[132:135], v[68:71]
  v_mfma_f32_16x16x32_bf16 v[68:71], v[176:179], v[148:151], v[68:71]
  ds_read_b128 v[196:199], v15 offset:2048
  ds_read_b128 v[200:203], v15 offset:4096
  s_add_u32 m0, s79, 49152
  s_nop 0
  buffer_load_dwordx4 v9, s[16:19], s68 offen  lds
  v_mfma_f32_16x16x32_bf16 v[72:75], v[160:163], v[136:139], v[72:75]
  v_mfma_f32_16x16x32_bf16 v[72:75], v[176:179], v[152:155], v[72:75]
  ds_read_b128 v[204:207], v15 offset:6144
  ds_read_b128 v[208:211], v16 offset:0
  v_mfma_f32_16x16x32_bf16 v[76:79], v[160:163], v[140:143], v[76:79]
  v_mfma_f32_16x16x32_bf16 v[76:79], v[176:179], v[156:159], v[76:79]
  ds_read_b128 v[212:215], v16 offset:2048
  ds_read_b128 v[216:219], v16 offset:4096
  s_add_u32 m0, s79, 50176
  s_nop 0
  buffer_load_dwordx4 v10, s[16:19], s68 offen  lds
  v_mfma_f32_16x16x32_bf16 v[80:83], v[164:167], v[128:131], v[80:83]
  v_mfma_f32_16x16x32_bf16 v[80:83], v[180:183], v[144:147], v[80:83]
  ds_read_b128 v[220:223], v16 offset:6144
  ds_read_b64_tr_b16 v[224:225], v19 offset:0
  v_mfma_f32_16x16x32_bf16 v[84:87], v[164:167], v[132:135], v[84:87]
  v_mfma_f32_16x16x32_bf16 v[84:87], v[180:183], v[148:151], v[84:87]
  ds_read_b64_tr_b16 v[226:227], v19 offset:1792
  ds_read_b64_tr_b16 v[228:229], v19 offset:14336
  s_add_u32 m0, s80, 65536
  s_add_u32 s68, s68, 128
  buffer_load_dwordx4 v11, s[20:23], s69 offen  lds
  v_mfma_f32_16x16x32_bf16 v[88:91], v[164:167], v[136:139], v[88:91]
  v_mfma_f32_16x16x32_bf16 v[88:91], v[180:183], v[152:155], v[88:91]
  ds_read_b64_tr_b16 v[230:231], v19 offset:16128
  ds_read_b64_tr_b16 v[232:233], v19 offset:32
  v_mfma_f32_16x16x32_bf16 v[92:95], v[164:167], v[140:143], v[92:95]
  v_mfma_f32_16x16x32_bf16 v[92:95], v[180:183], v[156:159], v[92:95]
  ds_read_b64_tr_b16 v[234:235], v19 offset:1824
  ds_read_b64_tr_b16 v[236:237], v19 offset:14368
  v_mfma_f32_16x16x32_bf16 v[96:99], v[168:171], v[128:131], v[96:99]
  v_mfma_f32_16x16x32_bf16 v[96:99], v[184:187], v[144:147], v[96:99]
  ds_read_b64_tr_b16 v[238:239], v19 offset:16160
  ds_read_b64_tr_b16 v[240:241], v20 offset:0
  s_add_u32 m0, s80, 66560
  s_nop 0
  buffer_load_dwordx4 v12, s[20:23], s69 offen  lds
  v_mfma_f32_16x16x32_bf16 v[100:103], v[168:171], v[132:135], v[100:103]
  v_mfma_f32_16x16x32_bf16 v[100:103], v[184:187], v[148:151], v[100:103]
  ds_read_b64_tr_b16 v[242:243], v20 offset:1792
  ds_read_b64_tr_b16 v[244:245], v20 offset:14336
  v_mfma_f32_16x16x32_bf16 v[104:107], v[168:171], v[136:139], v[104:107]
  v_mfma_f32_16x16x32_bf16 v[104:107], v[184:187], v[152:155], v[104:107]
  ds_read_b64_tr_b16 v[246:247], v20 offset:16128
  ds_read_b64_tr_b16 v[248:249], v20 offset:32
  s_add_u32 m0, s80, 67584
  s_nop 0
  buffer_load_dwordx4 v13, s[24:27], s69 offen  lds
  v_mfma_f32_16x16x32_bf16 v[108:111], v[168:171], v[140:143], v[108:111]
  v_mfma_f32_16x16x32_bf16 v[108:111], v[184:187], v[156:159], v[108:111]
  ds_read_b64_tr_b16 v[250:251], v20 offset:1824
  ds_read_b64_tr_b16 v[252:253], v20 offset:14368
  v_mfma_f32_16x16x32_bf16 v[112:115], v[172:175], v[128:131], v[112:115]
  v_mfma_f32_16x16x32_bf16 v[112:115], v[188:191], v[144:147], v[112:115]
  ds_read_b64_tr_b16 v[254:255], v20 offset:16160
  s_add_u32 m0, s80, 68608
  s_nop 0
  buffer_load_dwordx4 v14, s[24:27], s69 offen  lds
  s_add_u32 s69, s69, s70
  s_cmp_eq_u32 s68, 1024
  s_cselect_b32 s68, 0, s68
  s_cselect_b32 s69, 0, s69
  v_mfma_f32_16x16x32_bf16 v[116:119], v[172:175], v[132:135], v[116:119]
  v_mfma_f32_16x16x32_bf16 v[116:119], v[188:191], v[148:151], v[116:119]
  v_mfma_f32_16x16x32_bf16 v[120:123], v[172:175], v[136:139], v[120:123]
  v_mfma_f32_16x16x32_bf16 v[120:123], v[188:191], v[152:155], v[120:123]
  v_mfma_f32_16x16x32_bf16 v[124:127], v[172:175], v[140:143], v[124:127]
  v_mfma_f32_16x16x32_bf16 v[124:127], v[188:191], v[156:159], v[124:127]
  s_waitcnt vmcnt(6) lgkmcnt(0)
  s_barrier
  v_lshlrev_b32 v6, 2, v1
  s_cmp_eq_u32 s4, 0
  s_cselect_b32 s33, 0, 0x7ff00000
  v_add_u32 v6, s33, v6
  s_nop 0
  buffer_load_dword v23, v6, s[12:15], 0 offen sc1
  v_mfma_f32_16x16x32_bf16 v[64:67], v[224:227], v[192:195], v[64:67]
  v_mfma_f32_16x16x32_bf16 v[64:67], v[240:243], v[208:211], v[64:67]
  v_add_u32 v15, 0xfffe8000, v15
  v_add_u32 v16, 0xfffe8000, v16
  v_add_u32 v19, 0xfffe8000, v19
  v_add_u32 v20, 0xfffe8000, v20
  ds_read_b128 v[128:131], v15 offset:0
  v_mfma_f32_16x16x32_bf16 v[68:71], v[224:227], v[196:199], v[68:71]
  v_mfma_f32_16x16x32_bf16 v[68:71], v[240:243], v[212:215], v[68:71]
  ds_read_b128 v[132:135], v15 offset:2048
  ds_read_b128 v[136:139], v15 offset:4096
  v_lshrrev_b32 v5, 2, v3
  v_and_b32 v6, 3, v3
  v_lshl_add_u32 v5, v5, 3, v6
  v_lshlrev_b32 v5, 1, v5
  v_mfma_f32_16x16x32_bf16 v[72:75], v[224:227], v[200:203], v[72:75]
  v_mfma_f32_16x16x32_bf16 v[72:75], v[240:243], v[216:219], v[72:75]
  ds_read_b128 v[140:143], v15 offset:6144
  ds_read_b128 v[144:147], v16 offset:0
  v_lshrrev_b32 v6, 1, v4
  v_lshlrev_b32 v6, 14, v6
  v_and_b32 v8, 1, v4
  v_lshl_add_u32 v6, v8, 12, v6
  v_mfma_f32_16x16x32_bf16 v[76:79], v[224:227], v[204:207], v[76:79]
  v_mfma_f32_16x16x32_bf16 v[76:79], v[240:243], v[220:223], v[76:79]
  ds_read_b128 v[148:151], v16 offset:2048
  ds_read_b128 v[152:155], v16 offset:4096
  v_add_u32 v8, v6, v5
  v_lshl_add_u32 v7, v4, 12, v5
  s_cmp_eq_u32 s78, 1
  s_cselect_b64 vcc, -1, 0
  v_cndmask_b32 v7, v7, v8, vcc
  v_mfma_f32_16x16x32_bf16 v[80:83], v[228:231], v[192:195], v[80:83]
  v_mfma_f32_16x16x32_bf16 v[80:83], v[244:247], v[208:211], v[80:83]
  ds_read_b128 v[156:159], v16 offset:6144
  ds_read_b64_tr_b16 v[160:161], v19 offset:0
  buffer_load_ushort v24, v7, s[60:63], s75 offen offset:0
  v_mfma_f32_16x16x32_bf16 v[84:87], v[228:231], v[196:199], v[84:87]
  v_mfma_f32_16x16x32_bf16 v[84:87], v[244:247], v[212:215], v[84:87]
  ds_read_b64_tr_b16 v[162:163], v19 offset:1792
  ds_read_b64_tr_b16 v[164:165], v19 offset:14336
  buffer_load_ushort v25, v7, s[60:63], s75 offen offset:1024
  v_mfma_f32_16x16x32_bf16 v[88:91], v[228:231], v[200:203], v[88:91]
  v_mfma_f32_16x16x32_bf16 v[88:91], v[244:247], v[216:219], v[88:91]
  ds_read_b64_tr_b16 v[166:167], v19 offset:16128
  ds_read_b64_tr_b16 v[168:169], v19 offset:32
  buffer_load_ushort v26, v7, s[60:63], s75 offen offset:2048
  v_mfma_f32_16x16x32_bf16 v[92:95], v[228:231], v[204:207], v[92:95]
  v_mfma_f32_16x16x32_bf16 v[92:95], v[244:247], v[220:223], v[92:95]
  ds_read_b64_tr_b16 v[170:171], v19 offset:1824
  ds_read_b64_tr_b16 v[172:173], v19 offset:14368
  buffer_load_ushort v27, v7, s[60:63], s75 offen offset:3072
  v_mfma_f32_16x16x32_bf16 v[96:99], v[232:235], v[192:195], v[96:99]
  v_mfma_f32_16x16x32_bf16 v[96:99], v[248:251], v[208:211], v[96:99]
  ds_read_b64_tr_b16 v[174:175], v19 offset:16160
  ds_read_b64_tr_b16 v[176:177], v20 offset:0
  buffer_load_ushort v28, v7, s[60:63], s76 offen offset:0
  v_mfma_f32_16x16x32_bf16 v[100:103], v[232:235], v[196:199], v[100:103]
  v_mfma_f32_16x16x32_bf16 v[100:103], v[248:251], v[212:215], v[100:103]
  ds_read_b64_tr_b16 v[178:179], v20 offset:1792
  ds_read_b64_tr_b16 v[180:181], v20 offset:14336
  buffer_load_ushort v29, v7, s[60:63], s76 offen offset:1024
  v_mfma_f32_16x16x32_bf16 v[104:107], v[232:235], v[200:203], v[104:107]
  v_mfma_f32_16x16x32_bf16 v[104:107], v[248:251], v[216:219], v[104:107]
  ds_read_b64_tr_b16 v[182:183], v20 offset:16128
  ds_read_b64_tr_b16 v[184:185], v20 offset:32
  buffer_load_ushort v30, v7, s[60:63], s76 offen offset:2048
  v_mfma_f32_16x16x32_bf16 v[108:111], v[232:235], v[204:207], v[108:111]
  v_mfma_f32_16x16x32_bf16 v[108:111], v[248:251], v[220:223], v[108:111]
  ds_read_b64_tr_b16 v[186:187], v20 offset:1824
  ds_read_b64_tr_b16 v[188:189], v20 offset:14368
  buffer_load_ushort v31, v7, s[60:63], s76 offen offset:3072
  v_mfma_f32_16x16x32_bf16 v[112:115], v[236:239], v[192:195], v[112:115]
  v_mfma_f32_16x16x32_bf16 v[112:115], v[252:255], v[208:211], v[112:115]
  ds_read_b64_tr_b16 v[190:191], v20 offset:16160
  buffer_load_ushort v32, v8, s[64:67], s77 offen
  v_mfma_f32_16x16x32_bf16 v[116:119], v[236:239], v[196:199], v[116:119]
  v_mfma_f32_16x16x32_bf16 v[116:119], v[252:255], v[212:215], v[116:119]
  buffer_load_ushort v33, v8, s[64:67], s77 offen offset:1024
  v_mfma_f32_16x16x32_bf16 v[120:123], v[236:239], v[200:203], v[120:123]
  v_mfma_f32_16x16x32_bf16 v[120:123], v[252:255], v[216:219], v[120:123]
  v_mfma_f32_16x16x32_bf16 v[124:127], v[236:239], v[204:207], v[124:127]
  v_mfma_f32_16x16x32_bf16 v[124:127], v[252:255], v[220:223], v[124:127]
  s_waitcnt vmcnt(10) lgkmcnt(0)
  s_cmp_eq_u32 s4, 0
  s_cbranch_scc0 recurrent_scan__grouped_kv_mqa__swiglu_ffn__prompt_kernel_A6_nochk
  v_lshlrev_b32 v6, 2, v1
  s_mov_b32 s71, 0
recurrent_scan__grouped_kv_mqa__swiglu_ffn__prompt_kernel_A6f_ck:
  v_lshrrev_b32 v5, 0, v23
  v_and_b32 v5, 0x01010101, v5
  v_cmp_ne_u32 vcc, 0x01010101, v5
  s_add_u32 s71, s71, 1
  s_nop 3
  s_cbranch_vccz recurrent_scan__grouped_kv_mqa__swiglu_ffn__prompt_kernel_A6f_ok
  s_cmp_ge_u32 s71, 20000
  s_cbranch_scc1 recurrent_scan__grouped_kv_mqa__swiglu_ffn__prompt_kernel_A6f_ok
  s_sleep 1
  buffer_load_dword v23, v6, s[12:15], 0 offen sc1
  s_waitcnt vmcnt(0)
  s_branch recurrent_scan__grouped_kv_mqa__swiglu_ffn__prompt_kernel_A6f_ck
recurrent_scan__grouped_kv_mqa__swiglu_ffn__prompt_kernel_A6f_ok:
recurrent_scan__grouped_kv_mqa__swiglu_ffn__prompt_kernel_A6_nochk:
  s_barrier
  v_mfma_f32_16x16x32_bf16 v[64:67], v[160:163], v[128:131], v[64:67]
  v_mfma_f32_16x16x32_bf16 v[64:67], v[176:179], v[144:147], v[64:67]
  v_add_u32 v15, 0xc000, v15
  v_add_u32 v16, 0xc000, v16
  v_add_u32 v19, 0xc000, v19
  v_add_u32 v20, 0xc000, v20
  ds_read_b128 v[192:195], v15 offset:0
  v_mfma_f32_16x16x32_bf16 v[68:71], v[160:163], v[132:135], v[68:71]
  v_mfma_f32_16x16x32_bf16 v[68:71], v[176:179], v[148:151], v[68:71]
  ds_read_b128 v[196:199], v15 offset:2048
  ds_read_b128 v[200:203], v15 offset:4096
  s_lshl_b32 s33, s6, 14
  s_lshl_b32 s34, s32, 8
  s_add_u32 s33, s33, s34
  s_add_u32 s75, s33, 20971520
  s_lshl_b32 s33, s5, 14
  s_lshl_b32 s34, s4, 7
  s_add_u32 s33, s33, s34
  s_add_u32 s76, s33, 22020096
  v_lshlrev_b32 v7, 10, v4
  v_lshl_add_u32 v8, v3, 3, v7
  v_lshl_add_u32 v7, v3, 4, v7
  buffer_load_dwordx4 v[48:51], v7, s[8:11], s75 offen sc1
  s_add_u32 s75, s75, 4096
  v_mfma_f32_16x16x32_bf16 v[72:75], v[160:163], v[136:139], v[72:75]
  v_mfma_f32_16x16x32_bf16 v[72:75], v[176:179], v[152:155], v[72:75]
  ds_read_b128 v[204:207], v15 offset:6144
  ds_read_b128 v[208:211], v16 offset:0
  buffer_load_dwordx4 v[52:55], v7, s[8:11], s75 offen sc1
  s_add_u32 s75, s75, 4096
  v_mfma_f32_16x16x32_bf16 v[76:79], v[160:163], v[140:143], v[76:79]
  v_mfma_f32_16x16x32_bf16 v[76:79], v[176:179], v[156:159], v[76:79]
  ds_read_b128 v[212:215], v16 offset:2048
  ds_read_b128 v[216:219], v16 offset:4096
  buffer_load_dwordx4 v[56:59], v7, s[8:11], s75 offen sc1
  s_add_u32 s75, s75, 4096
  v_mfma_f32_16x16x32_bf16 v[80:83], v[164:167], v[128:131], v[80:83]
  v_mfma_f32_16x16x32_bf16 v[80:83], v[180:183], v[144:147], v[80:83]
  ds_read_b128 v[220:223], v16 offset:6144
  ds_read_b64_tr_b16 v[224:225], v19 offset:0
  buffer_load_dwordx4 v[60:63], v7, s[8:11], s75 offen sc1
  s_add_u32 s75, s75, 4096
  v_mfma_f32_16x16x32_bf16 v[84:87], v[164:167], v[132:135], v[84:87]
  v_mfma_f32_16x16x32_bf16 v[84:87], v[180:183], v[148:151], v[84:87]
  ds_read_b64_tr_b16 v[226:227], v19 offset:1792
  ds_read_b64_tr_b16 v[228:229], v19 offset:14336
  buffer_load_dwordx2 v[40:41], v8, s[8:11], s76 offen sc1
  s_add_u32 s76, s76, 4096
  v_mfma_f32_16x16x32_bf16 v[88:91], v[164:167], v[136:139], v[88:91]
  v_mfma_f32_16x16x32_bf16 v[88:91], v[180:183], v[152:155], v[88:91]
  ds_read_b64_tr_b16 v[230:231], v19 offset:16128
  ds_read_b64_tr_b16 v[232:233], v19 offset:32
  buffer_load_dwordx2 v[42:43], v8, s[8:11], s76 offen sc1
  s_add_u32 s76, s76, 4096
  v_mfma_f32_16x16x32_bf16 v[92:95], v[164:167], v[140:143], v[92:95]
  v_mfma_f32_16x16x32_bf16 v[92:95], v[180:183], v[156:159], v[92:95]
  ds_read_b64_tr_b16 v[234:235], v19 offset:1824
  ds_read_b64_tr_b16 v[236:237], v19 offset:14368
  buffer_load_dwordx2 v[44:45], v8, s[8:11], s76 offen sc1
  s_add_u32 s76, s76, 4096
  v_mfma_f32_16x16x32_bf16 v[96:99], v[168:171], v[128:131], v[96:99]
  v_mfma_f32_16x16x32_bf16 v[96:99], v[184:187], v[144:147], v[96:99]
  ds_read_b64_tr_b16 v[238:239], v19 offset:16160
  ds_read_b64_tr_b16 v[240:241], v20 offset:0
  buffer_load_dwordx2 v[46:47], v8, s[8:11], s76 offen sc1
  s_add_u32 s76, s76, 4096
  v_mfma_f32_16x16x32_bf16 v[100:103], v[168:171], v[132:135], v[100:103]
  v_mfma_f32_16x16x32_bf16 v[100:103], v[184:187], v[148:151], v[100:103]
  ds_read_b64_tr_b16 v[242:243], v20 offset:1792
  ds_read_b64_tr_b16 v[244:245], v20 offset:14336
  v_mfma_f32_16x16x32_bf16 v[104:107], v[168:171], v[136:139], v[104:107]
  v_mfma_f32_16x16x32_bf16 v[104:107], v[184:187], v[152:155], v[104:107]
  ds_read_b64_tr_b16 v[246:247], v20 offset:16128
  ds_read_b64_tr_b16 v[248:249], v20 offset:32
  v_mfma_f32_16x16x32_bf16 v[108:111], v[168:171], v[140:143], v[108:111]
  v_mfma_f32_16x16x32_bf16 v[108:111], v[184:187], v[156:159], v[108:111]
  ds_read_b64_tr_b16 v[250:251], v20 offset:1824
  ds_read_b64_tr_b16 v[252:253], v20 offset:14368
  v_mfma_f32_16x16x32_bf16 v[112:115], v[172:175], v[128:131], v[112:115]
  v_mfma_f32_16x16x32_bf16 v[112:115], v[188:191], v[144:147], v[112:115]
  ds_read_b64_tr_b16 v[254:255], v20 offset:16160
  v_mfma_f32_16x16x32_bf16 v[116:119], v[172:175], v[132:135], v[116:119]
  v_mfma_f32_16x16x32_bf16 v[116:119], v[188:191], v[148:151], v[116:119]
  v_mfma_f32_16x16x32_bf16 v[120:123], v[172:175], v[136:139], v[120:123]
  v_mfma_f32_16x16x32_bf16 v[120:123], v[188:191], v[152:155], v[120:123]
  v_mfma_f32_16x16x32_bf16 v[124:127], v[172:175], v[140:143], v[124:127]
  v_mfma_f32_16x16x32_bf16 v[124:127], v[188:191], v[156:159], v[124:127]
  s_waitcnt vmcnt(8) lgkmcnt(0)
  s_barrier
  s_mov_b32 s33, 0x5040100
  v_perm_b32 v24, v25, v24, s33
  v_perm_b32 v25, v27, v26, s33
  v_perm_b32 v26, v29, v28, s33
  v_perm_b32 v27, v31, v30, s33
  v_perm_b32 v32, v33, v32, s33
  buffer_store_dwordx4 v[24:27], v2, s[8:11], s73 offen sc1
  buffer_store_dword v32, v2, s[8:11], s74 offen sc1
  s_lshl_b32 s81, s4, 10
  v_mfma_f32_16x16x32_bf16 v[64:67], v[224:227], v[192:195], v[64:67]
  v_mfma_f32_16x16x32_bf16 v[64:67], v[240:243], v[208:211], v[64:67]
  v_mfma_f32_16x16x32_bf16 v[68:71], v[224:227], v[196:199], v[68:71]
  v_mfma_f32_16x16x32_bf16 v[68:71], v[240:243], v[212:215], v[68:71]
  s_mov_b32 m0, s81
  s_add_u32 s35, s81, 2097152
  s_add_u32 s81, s81, 8192
  buffer_load_dwordx4 v2, s[8:11], s35 offen  lds
  s_waitcnt vmcnt(3)
  v_mfma_f32_16x16x32_bf16 v[72:75], v[224:227], v[200:203], v[72:75]
  v_mfma_f32_16x16x32_bf16 v[72:75], v[240:243], v[216:219], v[72:75]
  v_pk_add_f32 v[40:41], v[40:41], v[42:43]
  v_pk_add_f32 v[44:45], v[44:45], v[46:47]
  v_pk_add_f32 v[48:49], v[48:49], v[52:53]
  v_pk_add_f32 v[50:51], v[50:51], v[54:55]
  s_mov_b32 m0, s81
  s_add_u32 s35, s81, 2097152
  s_add_u32 s81, s81, 8192
  buffer_load_dwordx4 v2, s[8:11], s35 offen  lds
  s_and_b32 s69, s4, 3
  s_lshr_b32 s70, s4, 2
  s_lshl_b32 s33, s70, 15
  v_add_u32 v7, s33, v2
  v_mov_b32 v10, 0xdddddddd
  v_mfma_f32_16x16x32_bf16 v[76:79], v[224:227], v[204:207], v[76:79]
  v_mfma_f32_16x16x32_bf16 v[76:79], v[240:243], v[220:223], v[76:79]
  v_pk_add_f32 v[56:57], v[56:57], v[60:61]
  v_pk_add_f32 v[58:59], v[58:59], v[62:63]
  v_pk_add_f32 v[40:41], v[40:41], v[44:45]
  s_nop 0
  v_and_b32 v5, 15, v1
  v_lshlrev_b32 v5, 4, v5
  v_lshrrev_b32 v6, 5, v1
  v_lshl_add_u32 v5, v6, 8, v5
  s_lshl_b32 s33, s70, 15
  s_add_u32 s33, s33, 65536
  v_add_u32 v8, s33, v5
  v_mfma_f32_16x16x32_bf16 v[80:83], v[228:231], v[192:195], v[80:83]
  v_mfma_f32_16x16x32_bf16 v[80:83], v[244:247], v[208:211], v[80:83]
  v_pk_add_f32 v[48:49], v[48:49], v[56:57]
  v_pk_add_f32 v[50:51], v[50:51], v[58:59]
  v_mfma_f32_16x16x4_f32 v[44:47], v18, v40, 0
  v_mfma_f32_16x16x4_f32 v[52:55], v18, v41, 0
  s_mov_b32 m0, s81
  s_add_u32 s35, s81, 2097152
  s_add_u32 s81, s81, 8192
  buffer_load_dwordx4 v2, s[8:11], s35 offen  lds
  s_mov_b32 s36, 0x0000ffff
  s_mov_b32 s37, 0x0000ffff
  v_and_b32 v5, 31, v1
  v_cmp_eq_u32 vcc, 16, v5
  v_cmp_eq_u32 s[38:39], 20, v5
  v_mov_b32 v6, 0x3f803f80
  v_mov_b32 v9, v2
  s_nop 1
  s_or_b64 vcc, vcc, s[38:39]
  v_cndmask_b32 v28, 0, v6, vcc
  v_mfma_f32_16x16x32_bf16 v[84:87], v[228:231], v[196:199], v[84:87]
  v_mfma_f32_16x16x32_bf16 v[84:87], v[244:247], v[212:215], v[84:87]
  v_mfma_f32_16x16x4_f32 v[56:59], v49, v18, 0
  v_mfma_f32_16x16x4_f32 v[60:63], v50, v18, 0
  v_mov_b32 v29, v28
  v_mov_b32 v30, v28
  v_mov_b32 v31, v28
  v_mov_b32 v32, v28
  v_mfma_f32_16x16x32_bf16 v[88:91], v[228:231], v[200:203], v[88:91]
  v_mfma_f32_16x16x32_bf16 v[88:91], v[244:247], v[216:219], v[88:91]
  s_nop 4
  v_mul_f32 v40, 0xbb000000, v44
  v_mul_f32 v42, 0x3b000000, v52
  v_fma_f32 v42, -v40, v40, v42
  v_max_f32 v42, 0, v42
  s_mov_b32 m0, s81
  s_add_u32 s35, s81, 2097152
  s_add_u32 s81, s81, 8192
  buffer_load_dwordx4 v2, s[8:11], s35 offen  lds
  v_mov_b32 v33, v28
  v_mov_b32 v34, v28
  v_mov_b32 v35, v28
  v_mfma_f32_16x16x32_bf16 v[92:95], v[228:231], v[204:207], v[92:95]
  v_mfma_f32_16x16x32_bf16 v[92:95], v[244:247], v[220:223], v[92:95]
  v_add_f32 v42, 0x3727c5ac, v42
  v_rsq_f32 v41, v42
  v_mov_b32 v43, 0
  s_lshl_b32 s33, s4, 8
  s_add_u32 s33, s33, 131072
  v_lshlrev_b32 v5, 4, v3
  v_add_u32 v5, s33, v5
  s_lshl_b32 s33, s69, 11
  s_lshl_b32 s34, s70, 10
  s_add_u32 s34, s34, s33
  s_add_u32 s33, s34, 135168
  v_add_u32 v11, s33, v2
  s_xor_b32 s34, s34, 1024
  s_add_u32 s33, s34, 135168
  v_add_u32 v12, s33, v2
  v_mfma_f32_16x16x32_bf16 v[96:99], v[232:235], v[192:195], v[96:99]
  v_mfma_f32_16x16x32_bf16 v[96:99], v[248:251], v[208:211], v[96:99]
  v_mfma_f32_16x16x4_f32 v[52:55], v48, v18, 0
  v_mfma_f32_16x16x4_f32 v[44:47], v51, v18, 0
  s_mov_b64 exec, 0xffff
  ds_write_b128 v5, v[40:43]
  s_mov_b64 exec, -1
  s_mov_b32 m0, s81
  s_add_u32 s35, s81, 2097152
  s_add_u32 s81, s81, 8192
  buffer_load_dwordx4 v2, s[8:11], s35 offen  lds
  v_mov_b32 v24, 0
  v_mov_b32 v25, 0
  v_mov_b32 v26, 0
  v_mov_b32 v27, 0
  v_mfma_f32_16x16x32_bf16 v[100:103], v[232:235], v[196:199], v[100:103]
  v_mfma_f32_16x16x32_bf16 v[100:103], v[248:251], v[212:215], v[100:103]
  s_mov_b32 m0, s81
  s_add_u32 s35, s81, 2097152
  s_add_u32 s81, s81, 8192
  buffer_load_dwordx4 v2, s[8:11], s35 offen  lds
  s_mov_b32 s24, s94
  s_mov_b32 s25, s95
  s_mov_b32 s26, 2097152
  s_mov_b32 s27, 0x20000
  v_and_b32 v6, 15, v1
  v_lshlrev_b32 v6, 10, v6
  v_lshrrev_b32 v13, 4, v1
  v_lshl_add_u32 v6, v13, 4, v6
  s_lshl_b32 s33, s42, 2
  s_add_u32 s33, s33, s41
  s_lshl_b32 s33, s33, 14
  s_lshl_b32 s34, s43, 7
  s_add_u32 s33, s33, s34
  s_lshl_b32 s34, s40, 6
  s_add_u32 s33, s33, s34
  v_add_u32 v13, s33, v6
  v_mfma_f32_16x16x32_bf16 v[104:107], v[232:235], v[200:203], v[104:107]
  v_mfma_f32_16x16x32_bf16 v[104:107], v[248:251], v[216:219], v[104:107]
  s_lshl_b32 s33, s43, 16
  s_lshl_b32 s34, s4, 10
  s_add_u32 s33, s33, s34
  s_add_u32 s75, s33, 14680064
  s_cmp_eq_u32 s4, 0
  s_cbranch_scc0 recurrent_scan__grouped_kv_mqa__swiglu_ffn__prompt_kernel_A7_noinit
  v_mov_b32 v5, 155648
  v_mov_b32 v6, 0
  ds_write_b32 v5, v6
  ds_write_b32 v5, v6 offset:4
  ds_write_b32 v5, v6 offset:8
recurrent_scan__grouped_kv_mqa__swiglu_ffn__prompt_kernel_A7_noinit:
  v_mfma_f32_16x16x32_bf16 v[108:111], v[232:235], v[204:207], v[108:111]
  v_mfma_f32_16x16x32_bf16 v[108:111], v[248:251], v[220:223], v[108:111]
  s_mov_b32 m0, s81
  s_add_u32 s35, s81, 2097152
  s_add_u32 s81, s81, 8192
  buffer_load_dwordx4 v2, s[8:11], s35 offen  lds
  v_mfma_f32_16x16x32_bf16 v[112:115], v[236:239], v[192:195], v[112:115]
  v_mfma_f32_16x16x32_bf16 v[112:115], v[252:255], v[208:211], v[112:115]
  v_mfma_f32_16x16x32_bf16 v[116:119], v[236:239], v[196:199], v[116:119]
  v_mfma_f32_16x16x32_bf16 v[116:119], v[252:255], v[212:215], v[116:119]
  s_mov_b32 m0, s81
  s_add_u32 s35, s81, 2097152
  s_add_u32 s81, s81, 8192
  buffer_load_dwordx4 v2, s[8:11], s35 offen  lds
  v_mfma_f32_16x16x32_bf16 v[120:123], v[236:239], v[200:203], v[120:123]
  v_mfma_f32_16x16x32_bf16 v[120:123], v[252:255], v[216:219], v[120:123]
  v_mfma_f32_16x16x32_bf16 v[124:127], v[236:239], v[204:207], v[124:127]
  v_mfma_f32_16x16x32_bf16 v[124:127], v[252:255], v[220:223], v[124:127]
  s_branch recurrent_scan__grouped_kv_mqa__swiglu_ffn__prompt_kernel_epi
recurrent_scan__grouped_kv_mqa__swiglu_ffn__prompt_kernel_mainB:
  ds_read_b128 v[128:131], v15 offset:0
  ds_read_b128 v[132:135], v15 offset:2048
  ds_read_b128 v[136:139], v15 offset:4096
  ds_read_b128 v[140:143], v15 offset:6144
  ds_read_b128 v[144:147], v16 offset:0
  ds_read_b128 v[148:151], v16 offset:2048
  ds_read_b128 v[152:155], v16 offset:4096
  ds_read_b128 v[156:159], v16 offset:6144
  ds_read_b64_tr_b16 v[160:161], v19 offset:0
  ds_read_b64_tr_b16 v[162:163], v19 offset:1792
  ds_read_b64_tr_b16 v[164:165], v19 offset:14336
  ds_read_b64_tr_b16 v[166:167], v19 offset:16128
  ds_read_b64_tr_b16 v[168:169], v21 offset:0
  ds_read_b64_tr_b16 v[170:171], v21 offset:256
  ds_read_b64_tr_b16 v[172:173], v21 offset:512
  ds_read_b64_tr_b16 v[174:175], v21 offset:768
  ds_read_b64_tr_b16 v[176:177], v20 offset:0
  ds_read_b64_tr_b16 v[178:179], v20 offset:1792
  ds_read_b64_tr_b16 v[180:181], v20 offset:14336
  ds_read_b64_tr_b16 v[182:183], v20 offset:16128
  ds_read_b64_tr_b16 v[184:185], v22 offset:0
  ds_read_b64_tr_b16 v[186:187], v22 offset:256
  ds_read_b64_tr_b16 v[188:189], v22 offset:512
  ds_read_b64_tr_b16 v[190:191], v22 offset:768
  ds_read_b128 v[232:235], v17
  s_add_u32 m0, s79, 98304
  s_nop 0
  buffer_load_dwordx4 v9, s[16:19], s68 offen  lds
  s_add_u32 m0, s79, 99328
  s_nop 0
  buffer_load_dwordx4 v10, s[16:19], s68 offen  lds
  s_add_u32 m0, s80, 114688
  s_add_u32 s68, s68, 128
  buffer_load_dwordx4 v11, s[20:23], s69 offen  lds
  s_add_u32 m0, s80, 115712
  s_nop 0
  buffer_load_dwordx4 v12, s[20:23], s69 offen  lds
  s_add_u32 m0, s80, 116736
  s_nop 0
  buffer_load_dwordx4 v13, s[24:27], s69 offen  lds
  s_add_u32 m0, s80, 117760
  s_nop 0
  buffer_load_dwordx4 v14, s[24:27], s69 offen  lds
  s_add_u32 s69, s69, s70
  s_cmp_eq_u32 s68, 1024
  s_cselect_b32 s68, 0, s68
  s_cselect_b32 s69, 0, s69
  s_waitcnt lgkmcnt(0)
  v_mfma_f32_16x16x32_bf16 v[48:51], v[36:39], v[160:163], 0
  v_mfma_f32_16x16x32_bf16 v[52:55], v[36:39], v[164:167], 0
  v_mfma_f32_16x16x32_bf16 v[56:59], v[36:39], v[168:171], 0
  v_mfma_f32_16x16x32_bf16 v[60:63], v[36:39], v[172:175], 0
  v_mfma_f32_16x16x32_bf16 v[40:43], v[36:39], v[232:235], 0
  v_mfma_f32_16x16x32_bf16 v[44:47], v[232:235], v[232:235], 0
  v_mfma_f32_16x16x32_bf16 v[64:67], v[160:163], v[128:131], v[64:67]
  v_mfma_f32_16x16x32_bf16 v[64:67], v[176:179], v[144:147], v[64:67]
  v_mfma_f32_16x16x32_bf16 v[68:71], v[160:163], v[132:135], v[68:71]
  v_mfma_f32_16x16x32_bf16 v[68:71], v[176:179], v[148:151], v[68:71]
  v_mfma_f32_16x16x32_bf16 v[72:75], v[160:163], v[136:139], v[72:75]
  v_mfma_f32_16x16x32_bf16 v[72:75], v[176:179], v[152:155], v[72:75]
  v_mfma_f32_16x16x32_bf16 v[76:79], v[160:163], v[140:143], v[76:79]
  v_mfma_f32_16x16x32_bf16 v[76:79], v[176:179], v[156:159], v[76:79]
  v_mfma_f32_16x16x32_bf16 v[80:83], v[164:167], v[128:131], v[80:83]
  v_mfma_f32_16x16x32_bf16 v[80:83], v[180:183], v[144:147], v[80:83]
  s_waitcnt vmcnt(12)
  ds_read_b64_tr_b16 v[200:201], v228 offset:0
  ds_read_b64_tr_b16 v[202:203], v228 offset:256
  ds_read_b64_tr_b16 v[204:205], v228 offset:1024
  ds_read_b64_tr_b16 v[206:207], v228 offset:1280
  s_waitcnt lgkmcnt(0)
  s_cmp_ge_u32 s6, 8
  s_cbranch_scc1 recurrent_scan__grouped_kv_mqa__swiglu_ffn__prompt_kernel_B0_p0v
  v_mfma_f32_16x16x32_bf16 v[208:211], v[200:203], v[192:195], 0
  v_mfma_f32_16x16x32_bf16 v[212:215], v[200:203], v[36:39], 0
  v_mfma_f32_16x16x32_bf16 v[216:219], v[36:39], v[192:195], 0
  v_mfma_f32_16x16x32_bf16 v[220:223], v[192:195], v[192:195], 0
  v_mfma_f32_16x16x32_bf16 v[208:211], v[204:207], v[196:199], v[208:211]
  v_mfma_f32_16x16x32_bf16 v[212:215], v[204:207], v[36:39], v[212:215]
  v_mfma_f32_16x16x32_bf16 v[216:219], v[36:39], v[196:199], v[216:219]
  v_mfma_f32_16x16x32_bf16 v[220:223], v[196:199], v[196:199], v[220:223]
  s_branch recurrent_scan__grouped_kv_mqa__swiglu_ffn__prompt_kernel_B0_p0w
recurrent_scan__grouped_kv_mqa__swiglu_ffn__prompt_kernel_B0_p0v:
  v_mfma_f32_16x16x32_bf16 v[208:211], v[192:195], v[200:203], 0
  v_mfma_f32_16x16x32_bf16 v[212:215], v[192:195], v[36:39], 0
  v_mfma_f32_16x16x32_bf16 v[216:219], v[36:39], v[200:203], 0
  v_mfma_f32_16x16x32_bf16 v[220:223], v[192:195], v[192:195], 0
  v_mfma_f32_16x16x32_bf16 v[208:211], v[196:199], v[204:207], v[208:211]
  v_mfma_f32_16x16x32_bf16 v[212:215], v[196:199], v[36:39], v[212:215]
  v_mfma_f32_16x16x32_bf16 v[216:219], v[36:39], v[204:207], v[216:219]
  v_mfma_f32_16x16x32_bf16 v[220:223], v[196:199], v[196:199], v[220:223]
recurrent_scan__grouped_kv_mqa__swiglu_ffn__prompt_kernel_B0_p0w:
  s_add_u32 s33, s79, 147456
  v_add_u32 v5, s33, v2
  v_lshlrev_b32 v6, 4, v4
  v_add_u32 v6, s33, v6
  v_lshlrev_b32 v7, 2, v3
  v_add_u32 v7, s33, v7
  s_nop 3
  v_cndmask_b32 v8, v220, v221, s[86:87]
  v_cndmask_b32 v8, v8, v222, s[88:89]
  v_cndmask_b32 v8, v8, v223, s[90:91]
  ds_write_b128 v5, v[208:211]
  s_mov_b64 exec, s[84:85]
  ds_write_b32 v7, v8 offset:1152
  s_mov_b32 s33, 0x00010001
  s_mov_b32 exec_lo, s33
  s_mov_b32 exec_hi, s33
  ds_write_b128 v6, v[212:215] offset:1024
  s_mov_b64 exec, 0xffff
  ds_write_b32 v7, v216 offset:1088
  s_mov_b64 exec, -1
  s_waitcnt vmcnt(6) lgkmcnt(0)
  s_barrier
  v_mfma_f32_16x16x32_bf16 v[84:87], v[164:167], v[132:135], v[84:87]
  v_mfma_f32_16x16x32_bf16 v[84:87], v[180:183], v[148:151], v[84:87]
  v_add_u32 v15, 0xc000, v15
  v_add_u32 v16, 0xc000, v16
  v_add_u32 v19, 0xc000, v19
  v_add_u32 v20, 0xc000, v20
  v_add_u32 v21, 0xc000, v21
  v_add_u32 v22, 0xc000, v22
  ds_read_b128 v[192:195], v15 offset:0
  v_mfma_f32_16x16x32_bf16 v[88:91], v[164:167], v[136:139], v[88:91]
  v_mfma_f32_16x16x32_bf16 v[88:91], v[180:183], v[152:155], v[88:91]
  ds_read_b128 v[196:199], v15 offset:2048
  ds_read_b128 v[200:203], v15 offset:4096
  ds_read_b128 v[204:207], v15 offset:6144
  s_add_u32 m0, s79, 0
  s_nop 0
  buffer_load_dwordx4 v9, s[16:19], s68 offen  lds
  v_mfma_f32_16x16x32_bf16 v[92:95], v[164:167], v[140:143], v[92:95]
  v_mfma_f32_16x16x32_bf16 v[92:95], v[180:183], v[156:159], v[92:95]
  ds_read_b128 v[208:211], v16 offset:0
  ds_read_b128 v[212:215], v16 offset:2048
  ds_read_b128 v[216:219], v16 offset:4096
  s_add_u32 m0, s79, 1024
  s_nop 0
  buffer_load_dwordx4 v10, s[16:19], s68 offen  lds
  v_mfma_f32_16x16x32_bf16 v[96:99], v[168:171], v[128:131], v[96:99]
  v_mfma_f32_16x16x32_bf16 v[96:99], v[184:187], v[144:147], v[96:99]
  ds_read_b128 v[220:223], v16 offset:6144
  ds_read_b64_tr_b16 v[224:225], v19 offset:0
  ds_read_b64_tr_b16 v[226:227], v19 offset:1792
  v_mfma_f32_16x16x32_bf16 v[100:103], v[168:171], v[132:135], v[100:103]
  v_mfma_f32_16x16x32_bf16 v[100:103], v[184:187], v[148:151], v[100:103]
  ds_read_b64_tr_b16 v[228:229], v19 offset:14336
  ds_read_b64_tr_b16 v[230:231], v19 offset:16128
  ds_read_b64_tr_b16 v[232:233], v21 offset:0
  s_add_u32 m0, s80, 16384
  s_add_u32 s68, s68, 128
  buffer_load_dwordx4 v11, s[20:23], s69 offen  lds
  v_mfma_f32_16x16x32_bf16 v[104:107], v[168:171], v[136:139], v[104:107]
  v_mfma_f32_16x16x32_bf16 v[104:107], v[184:187], v[152:155], v[104:107]
  ds_read_b64_tr_b16 v[234:235], v21 offset:256
  ds_read_b64_tr_b16 v[236:237], v21 offset:512
  ds_read_b64_tr_b16 v[238:239], v21 offset:768
  s_add_u32 m0, s80, 17408
  s_nop 0
  buffer_load_dwordx4 v12, s[20:23], s69 offen  lds
  v_mfma_f32_16x16x32_bf16 v[108:111], v[168:171], v[140:143], v[108:111]
  v_mfma_f32_16x16x32_bf16 v[108:111], v[184:187], v[156:159], v[108:111]
  ds_read_b64_tr_b16 v[240:241], v20 offset:0
  ds_read_b64_tr_b16 v[242:243], v20 offset:1792
  ds_read_b64_tr_b16 v[244:245], v20 offset:14336
  v_mfma_f32_16x16x32_bf16 v[112:115], v[172:175], v[128:131], v[112:115]
  v_mfma_f32_16x16x32_bf16 v[112:115], v[188:191], v[144:147], v[112:115]
  ds_read_b64_tr_b16 v[246:247], v20 offset:16128
  ds_read_b64_tr_b16 v[248:249], v22 offset:0
  ds_read_b64_tr_b16 v[250:251], v22 offset:256
  s_add_u32 m0, s80, 18432
  s_nop 0
  buffer_load_dwordx4 v13, s[24:27], s69 offen  lds
  v_mfma_f32_16x16x32_bf16 v[116:119], v[172:175], v[132:135], v[116:119]
  v_mfma_f32_16x16x32_bf16 v[116:119], v[188:191], v[148:151], v[116:119]
  ds_read_b64_tr_b16 v[252:253], v22 offset:512
  ds_read_b64_tr_b16 v[254:255], v22 offset:768
  s_add_u32 m0, s80, 19456
  s_nop 0
  buffer_load_dwordx4 v14, s[24:27], s69 offen  lds
  s_add_u32 s69, s69, s70
  s_cmp_eq_u32 s68, 1024
  s_cselect_b32 s68, 0, s68
  s_cselect_b32 s69, 0, s69
  v_mfma_f32_16x16x32_bf16 v[120:123], v[172:175], v[136:139], v[120:123]
  v_mfma_f32_16x16x32_bf16 v[120:123], v[188:191], v[152:155], v[120:123]
  v_mfma_f32_16x16x32_bf16 v[124:127], v[172:175], v[140:143], v[124:127]
  v_mfma_f32_16x16x32_bf16 v[124:127], v[188:191], v[156:159], v[124:127]
  v_mov_b32 v49, v52
  v_mov_b32 v50, v56
  v_mov_b32 v51, v60
  s_lshl_b32 s33, s6, 4
  s_add_u32 s33, s33, s82
  s_lshl_b32 s33, s33, 2
  s_add_u32 s33, s33, s32
  s_lshl_b32 s33, s33, 8
  s_add_u32 s33, s33, 20971520
  s_and_b32 s34, s82, 1
  s_cmp_eq_u32 s34, s7
  s_cselect_b32 s33, s33, 0x7ff00000
  v_mov_b32 v6, 0x7ff00000
  v_cmp_gt_u32 vcc, 16, v1
  v_cndmask_b32 v8, v44, v45, s[86:87]
  v_cndmask_b32 v8, v8, v46, s[88:89]
  v_cndmask_b32 v5, v6, v2, vcc
  v_cndmask_b32 v41, v8, v47, s[90:91]
  buffer_store_dwordx4 v[48:51], v5, s[8:11], s33 offen sc1
  s_lshl_b32 s33, s5, 4
  s_add_u32 s33, s33, s82
  s_lshl_b32 s33, s33, 3
  s_add_u32 s33, s33, s4
  s_lshl_b32 s33, s33, 7
  s_add_u32 s33, s33, 22020096
  v_lshlrev_b32 v7, 3, v3
  v_cndmask_b32 v7, v6, v7, s[84:85]
  s_nop 0
  buffer_store_dwordx2 v[40:41], v7, s[8:11], s33 offen sc1
  v_bfe_u32 v5, v1, 4, 1
  v_lshlrev_b32 v5, 14, v5
  v_lshrrev_b32 v6, 5, v1
  v_lshl_add_u32 v5, v6, 8, v5
  v_and_b32 v6, 15, v1
  v_lshl_add_u32 v5, v6, 4, v5
  s_lshl_b32 s33, s5, 3
  s_lshl_b32 s34, s32, 1
  s_add_u32 s33, s33, s34
  s_lshl_b32 s33, s33, 4
  s_add_u32 s33, s33, s6
  s_lshl_b32 s33, s33, 10
  s_lshl_b32 s34, s7, 9
  s_add_u32 s33, s33, s34
  s_add_u32 s33, s33, 15728640
  v_mov_b32 v52, -1
  v_mov_b32 v53, -1
  v_mov_b32 v54, -1
  v_mov_b32 v55, -1
  buffer_store_dwordx4 v[52:55], v5, s[8:11], s33 offen sc1
  s_waitcnt vmcnt(9) lgkmcnt(0)
  s_barrier
  v_mfma_f32_16x16x32_bf16 v[64:67], v[224:227], v[192:195], v[64:67]
  v_mfma_f32_16x16x32_bf16 v[64:67], v[240:243], v[208:211], v[64:67]
  v_add_u32 v15, 0xc000, v15
  v_add_u32 v16, 0xc000, v16
  v_add_u32 v19, 0xc000, v19
  v_add_u32 v20, 0xc000, v20
  v_add_u32 v21, 0xc000, v21
  v_add_u32 v22, 0xc000, v22
  ds_read_b128 v[128:131], v15 offset:0
  v_mfma_f32_16x16x32_bf16 v[68:71], v[224:227], v[196:199], v[68:71]
  v_mfma_f32_16x16x32_bf16 v[68:71], v[240:243], v[212:215], v[68:71]
  ds_read_b128 v[132:135], v15 offset:2048
  ds_read_b128 v[136:139], v15 offset:4096
  s_add_u32 m0, s79, 49152
  s_nop 0
  buffer_load_dwordx4 v9, s[16:19], s68 offen  lds
  v_mfma_f32_16x16x32_bf16 v[72:75], v[224:227], v[200:203], v[72:75]
  v_mfma_f32_16x16x32_bf16 v[72:75], v[240:243], v[216:219], v[72:75]
  ds_read_b128 v[140:143], v15 offset:6144
  ds_read_b128 v[144:147], v16 offset:0
  v_mfma_f32_16x16x32_bf16 v[76:79], v[224:227], v[204:207], v[76:79]
  v_mfma_f32_16x16x32_bf16 v[76:79], v[240:243], v[220:223], v[76:79]
  ds_read_b128 v[148:151], v16 offset:2048
  ds_read_b128 v[152:155], v16 offset:4096
  s_add_u32 m0, s79, 50176
  s_nop 0
  buffer_load_dwordx4 v10, s[16:19], s68 offen  lds
  v_mfma_f32_16x16x32_bf16 v[80:83], v[228:231], v[192:195], v[80:83]
  v_mfma_f32_16x16x32_bf16 v[80:83], v[244:247], v[208:211], v[80:83]
  ds_read_b128 v[156:159], v16 offset:6144
  ds_read_b64_tr_b16 v[160:161], v19 offset:0
  v_mfma_f32_16x16x32_bf16 v[84:87], v[228:231], v[196:199], v[84:87]
  v_mfma_f32_16x16x32_bf16 v[84:87], v[244:247], v[212:215], v[84:87]
  ds_read_b64_tr_b16 v[162:163], v19 offset:1792
  ds_read_b64_tr_b16 v[164:165], v19 offset:14336
  s_add_u32 m0, s80, 65536
  s_add_u32 s68, s68, 128
  buffer_load_dwordx4 v11, s[20:23], s69 offen  lds
  v_mfma_f32_16x16x32_bf16 v[88:91], v[228:231], v[200:203], v[88:91]
  v_mfma_f32_16x16x32_bf16 v[88:91], v[244:247], v[216:219], v[88:91]
  ds_read_b64_tr_b16 v[166:167], v19 offset:16128
  ds_read_b64_tr_b16 v[168:169], v21 offset:0
  v_mfma_f32_16x16x32_bf16 v[92:95], v[228:231], v[204:207], v[92:95]
  v_mfma_f32_16x16x32_bf16 v[92:95], v[244:247], v[220:223], v[92:95]
  ds_read_b64_tr_b16 v[170:171], v21 offset:256
  ds_read_b64_tr_b16 v[172:173], v21 offset:512
  v_mfma_f32_16x16x32_bf16 v[96:99], v[232:235], v[192:195], v[96:99]
  v_mfma_f32_16x16x32_bf16 v[96:99], v[248:251], v[208:211], v[96:99]
  ds_read_b64_tr_b16 v[174:175], v21 offset:768
  ds_read_b64_tr_b16 v[176:177], v20 offset:0
  s_add_u32 m0, s80, 66560
  s_nop 0
  buffer_load_dwordx4 v12, s[20:23], s69 offen  lds
  v_mfma_f32_16x16x32_bf16 v[100:103], v[232:235], v[196:199], v[100:103]
  v_mfma_f32_16x16x32_bf16 v[100:103], v[248:251], v[212:215], v[100:103]
  ds_read_b64_tr_b16 v[178:179], v20 offset:1792
  ds_read_b64_tr_b16 v[180:181], v20 offset:14336
  v_mfma_f32_16x16x32_bf16 v[104:107], v[232:235], v[200:203], v[104:107]
  v_mfma_f32_16x16x32_bf16 v[104:107], v[248:251], v[216:219], v[104:107]
  ds_read_b64_tr_b16 v[182:183], v20 offset:16128
  ds_read_b64_tr_b16 v[184:185], v22 offset:0
  s_add_u32 m0, s80, 67584
  s_nop 0
  buffer_load_dwordx4 v13, s[24:27], s69 offen  lds
  v_mfma_f32_16x16x32_bf16 v[108:111], v[232:235], v[204:207], v[108:111]
  v_mfma_f32_16x16x32_bf16 v[108:111], v[248:251], v[220:223], v[108:111]
  ds_read_b64_tr_b16 v[186:187], v22 offset:256
  ds_read_b64_tr_b16 v[188:189], v22 offset:512
  v_mfma_f32_16x16x32_bf16 v[112:115], v[236:239], v[192:195], v[112:115]
  v_mfma_f32_16x16x32_bf16 v[112:115], v[252:255], v[208:211], v[112:115]
  ds_read_b64_tr_b16 v[190:191], v22 offset:768
  s_add_u32 m0, s80, 68608
  s_nop 0
  buffer_load_dwordx4 v14, s[24:27], s69 offen  lds
  s_add_u32 s69, s69, s70
  s_cmp_eq_u32 s68, 1024
  s_cselect_b32 s68, 0, s68
  s_cselect_b32 s69, 0, s69
  v_mfma_f32_16x16x32_bf16 v[116:119], v[236:239], v[196:199], v[116:119]
  v_mfma_f32_16x16x32_bf16 v[116:119], v[252:255], v[212:215], v[116:119]
  v_mfma_f32_16x16x32_bf16 v[120:123], v[236:239], v[200:203], v[120:123]
  v_mfma_f32_16x16x32_bf16 v[120:123], v[252:255], v[216:219], v[120:123]
  v_mfma_f32_16x16x32_bf16 v[124:127], v[236:239], v[204:207], v[124:127]
  v_mfma_f32_16x16x32_bf16 v[124:127], v[252:255], v[220:223], v[124:127]
  v_mov_b32 v5, 0x7ff00000
  s_nop 0
  buffer_store_dwordx2 v[192:193], v5, s[8:11], 0 offen sc1
  s_waitcnt vmcnt(10) lgkmcnt(0)
  s_barrier
  v_mfma_f32_16x16x32_bf16 v[64:67], v[160:163], v[128:131], v[64:67]
  v_mfma_f32_16x16x32_bf16 v[64:67], v[176:179], v[144:147], v[64:67]
  v_add_u32 v15, 0xfffe8000, v15
  v_add_u32 v16, 0xfffe8000, v16
  v_add_u32 v19, 0xfffe8000, v19
  v_add_u32 v20, 0xfffe8000, v20
  v_add_u32 v21, 0xfffe8000, v21
  v_add_u32 v22, 0xfffe8000, v22
  ds_read_b128 v[192:195], v15 offset:0
  v_mfma_f32_16x16x32_bf16 v[68:71], v[160:163], v[132:135], v[68:71]
  v_mfma_f32_16x16x32_bf16 v[68:71], v[176:179], v[148:151], v[68:71]
  ds_read_b128 v[196:199], v15 offset:2048
  ds_read_b128 v[200:203], v15 offset:4096
  s_add_u32 m0, s79, 98304
  s_nop 0
  buffer_load_dwordx4 v9, s[16:19], s68 offen  lds
  v_mfma_f32_16x16x32_bf16 v[72:75], v[160:163], v[136:139], v[72:75]
  v_mfma_f32_16x16x32_bf16 v[72:75], v[176:179], v[152:155], v[72:75]
  ds_read_b128 v[204:207], v15 offset:6144
  ds_read_b128 v[208:211], v16 offset:0
  v_mfma_f32_16x16x32_bf16 v[76:79], v[160:163], v[140:143], v[76:79]
  v_mfma_f32_16x16x32_bf16 v[76:79], v[176:179], v[156:159], v[76:79]
  ds_read_b128 v[212:215], v16 offset:2048
  ds_read_b128 v[216:219], v16 offset:4096
  s_add_u32 m0, s79, 99328
  s_nop 0
  buffer_load_dwordx4 v10, s[16:19], s68 offen  lds
  v_mfma_f32_16x16x32_bf16 v[80:83], v[164:167], v[128:131], v[80:83]
  v_mfma_f32_16x16x32_bf16 v[80:83], v[180:183], v[144:147], v[80:83]
  ds_read_b128 v[220:223], v16 offset:6144
  ds_read_b64_tr_b16 v[224:225], v19 offset:0
  v_mfma_f32_16x16x32_bf16 v[84:87], v[164:167], v[132:135], v[84:87]
  v_mfma_f32_16x16x32_bf16 v[84:87], v[180:183], v[148:151], v[84:87]
  ds_read_b64_tr_b16 v[226:227], v19 offset:1792
  ds_read_b64_tr_b16 v[228:229], v19 offset:14336
  s_add_u32 m0, s80, 114688
  s_add_u32 s68, s68, 128
  buffer_load_dwordx4 v11, s[20:23], s69 offen  lds
  v_mfma_f32_16x16x32_bf16 v[88:91], v[164:167], v[136:139], v[88:91]
  v_mfma_f32_16x16x32_bf16 v[88:91], v[180:183], v[152:155], v[88:91]
  ds_read_b64_tr_b16 v[230:231], v19 offset:16128
  ds_read_b64_tr_b16 v[232:233], v21 offset:0
  v_mfma_f32_16x16x32_bf16 v[92:95], v[164:167], v[140:143], v[92:95]
  v_mfma_f32_16x16x32_bf16 v[92:95], v[180:183], v[156:159], v[92:95]
  ds_read_b64_tr_b16 v[234:235], v21 offset:256
  ds_read_b64_tr_b16 v[236:237], v21 offset:512
  v_mfma_f32_16x16x32_bf16 v[96:99], v[168:171], v[128:131], v[96:99]
  v_mfma_f32_16x16x32_bf16 v[96:99], v[184:187], v[144:147], v[96:99]
  ds_read_b64_tr_b16 v[238:239], v21 offset:768
  ds_read_b64_tr_b16 v[240:241], v20 offset:0
  s_add_u32 m0, s80, 115712
  s_nop 0
  buffer_load_dwordx4 v12, s[20:23], s69 offen  lds
  v_mfma_f32_16x16x32_bf16 v[100:103], v[168:171], v[132:135], v[100:103]
  v_mfma_f32_16x16x32_bf16 v[100:103], v[184:187], v[148:151], v[100:103]
  ds_read_b64_tr_b16 v[242:243], v20 offset:1792
  ds_read_b64_tr_b16 v[244:245], v20 offset:14336
  v_mfma_f32_16x16x32_bf16 v[104:107], v[168:171], v[136:139], v[104:107]
  v_mfma_f32_16x16x32_bf16 v[104:107], v[184:187], v[152:155], v[104:107]
  ds_read_b64_tr_b16 v[246:247], v20 offset:16128
  ds_read_b64_tr_b16 v[248:249], v22 offset:0
  s_add_u32 m0, s80, 116736
  s_nop 0
  buffer_load_dwordx4 v13, s[24:27], s69 offen  lds
  v_mfma_f32_16x16x32_bf16 v[108:111], v[168:171], v[140:143], v[108:111]
  v_mfma_f32_16x16x32_bf16 v[108:111], v[184:187], v[156:159], v[108:111]
  ds_read_b64_tr_b16 v[250:251], v22 offset:256
  ds_read_b64_tr_b16 v[252:253], v22 offset:512
  v_mfma_f32_16x16x32_bf16 v[112:115], v[172:175], v[128:131], v[112:115]
  v_mfma_f32_16x16x32_bf16 v[112:115], v[188:191], v[144:147], v[112:115]
  ds_read_b64_tr_b16 v[254:255], v22 offset:768
  s_add_u32 m0, s80, 117760
  s_nop 0
  buffer_load_dwordx4 v14, s[24:27], s69 offen  lds
  s_add_u32 s69, s69, s70
  s_cmp_eq_u32 s68, 1024
  s_cselect_b32 s68, 0, s68
  s_cselect_b32 s69, 0, s69
  v_mfma_f32_16x16x32_bf16 v[116:119], v[172:175], v[132:135], v[116:119]
  v_mfma_f32_16x16x32_bf16 v[116:119], v[188:191], v[148:151], v[116:119]
  v_mfma_f32_16x16x32_bf16 v[120:123], v[172:175], v[136:139], v[120:123]
  v_mfma_f32_16x16x32_bf16 v[120:123], v[188:191], v[152:155], v[120:123]
  v_mfma_f32_16x16x32_bf16 v[124:127], v[172:175], v[140:143], v[124:127]
  v_mfma_f32_16x16x32_bf16 v[124:127], v[188:191], v[156:159], v[124:127]
  s_waitcnt vmcnt(6) lgkmcnt(0)
  s_barrier
  s_lshl_b32 s33, s5, 4
  s_add_u32 s33, s33, s6
  s_and_b32 s34, s33, 3
  s_lshl_b32 s34, s34, 3
  s_lshl_b32 s34, 1, s34
  s_and_b32 s33, s33, 0xfc
  s_cmp_eq_u32 s4, 0
  s_cselect_b32 s33, s33, 0x7ff00000
  v_mov_b32 v5, s34
  v_mov_b32 v6, s33
  s_mov_b64 exec, 1
  buffer_atomic_or v5, v6, s[12:15], 0 offen sc1
  s_mov_b64 exec, -1
  v_mfma_f32_16x16x32_bf16 v[64:67], v[224:227], v[192:195], v[64:67]
  v_mfma_f32_16x16x32_bf16 v[64:67], v[240:243], v[208:211], v[64:67]
  v_add_u32 v15, 0xc000, v15
  v_add_u32 v16, 0xc000, v16
  v_add_u32 v19, 0xc000, v19
  v_add_u32 v20, 0xc000, v20
  v_add_u32 v21, 0xc000, v21
  v_add_u32 v22, 0xc000, v22
  ds_read_b128 v[128:131], v15 offset:0
  v_mfma_f32_16x16x32_bf16 v[68:71], v[224:227], v[196:199], v[68:71]
  v_mfma_f32_16x16x32_bf16 v[68:71], v[240:243], v[212:215], v[68:71]
  ds_read_b128 v[132:135], v15 offset:2048
  ds_read_b128 v[136:139], v15 offset:4096
  s_add_u32 m0, s79, 0
  s_nop 0
  buffer_load_dwordx4 v9, s[16:19], s68 offen  lds
  v_mfma_f32_16x16x32_bf16 v[72:75], v[224:227], v[200:203], v[72:75]
  v_mfma_f32_16x16x32_bf16 v[72:75], v[240:243], v[216:219], v[72:75]
  ds_read_b128 v[140:143], v15 offset:6144
  ds_read_b128 v[144:147], v16 offset:0
  v_mfma_f32_16x16x32_bf16 v[76:79], v[224:227], v[204:207], v[76:79]
  v_mfma_f32_16x16x32_bf16 v[76:79], v[240:243], v[220:223], v[76:79]
  ds_read_b128 v[148:151], v16 offset:2048
  ds_read_b128 v[152:155], v16 offset:4096
  s_add_u32 m0, s79, 1024
  s_nop 0
  buffer_load_dwordx4 v10, s[16:19], s68 offen  lds
  v_mfma_f32_16x16x32_bf16 v[80:83], v[228:231], v[192:195], v[80:83]
  v_mfma_f32_16x16x32_bf16 v[80:83], v[244:247], v[208:211], v[80:83]
  ds_read_b128 v[156:159], v16 offset:6144
  ds_read_b64_tr_b16 v[160:161], v19 offset:0
  v_mfma_f32_16x16x32_bf16 v[84:87], v[228:231], v[196:199], v[84:87]
  v_mfma_f32_16x16x32_bf16 v[84:87], v[244:247], v[212:215], v[84:87]
  ds_read_b64_tr_b16 v[162:163], v19 offset:1792
  ds_read_b64_tr_b16 v[164:165], v19 offset:14336
  s_add_u32 m0, s80, 16384
  s_add_u32 s68, s68, 128
  buffer_load_dwordx4 v11, s[20:23], s69 offen  lds
  v_mfma_f32_16x16x32_bf16 v[88:91], v[228:231], v[200:203], v[88:91]
  v_mfma_f32_16x16x32_bf16 v[88:91], v[244:247], v[216:219], v[88:91]
  ds_read_b64_tr_b16 v[166:167], v19 offset:16128
  ds_read_b64_tr_b16 v[168:169], v21 offset:0
  v_mfma_f32_16x16x32_bf16 v[92:95], v[228:231], v[204:207], v[92:95]
  v_mfma_f32_16x16x32_bf16 v[92:95], v[244:247], v[220:223], v[92:95]
  ds_read_b64_tr_b16 v[170:171], v21 offset:256
  ds_read_b64_tr_b16 v[172:173], v21 offset:512
  v_mfma_f32_16x16x32_bf16 v[96:99], v[232:235], v[192:195], v[96:99]
  v_mfma_f32_16x16x32_bf16 v[96:99], v[248:251], v[208:211], v[96:99]
  ds_read_b64_tr_b16 v[174:175], v21 offset:768
  ds_read_b64_tr_b16 v[176:177], v20 offset:0
  s_add_u32 m0, s80, 17408
  s_nop 0
  buffer_load_dwordx4 v12, s[20:23], s69 offen  lds
  v_mfma_f32_16x16x32_bf16 v[100:103], v[232:235], v[196:199], v[100:103]
  v_mfma_f32_16x16x32_bf16 v[100:103], v[248:251], v[212:215], v[100:103]
  ds_read_b64_tr_b16 v[178:179], v20 offset:1792
  ds_read_b64_tr_b16 v[180:181], v20 offset:14336
  v_mfma_f32_16x16x32_bf16 v[104:107], v[232:235], v[200:203], v[104:107]
  v_mfma_f32_16x16x32_bf16 v[104:107], v[248:251], v[216:219], v[104:107]
  ds_read_b64_tr_b16 v[182:183], v20 offset:16128
  ds_read_b64_tr_b16 v[184:185], v22 offset:0
  s_add_u32 m0, s80, 18432
  s_nop 0
  buffer_load_dwordx4 v13, s[24:27], s69 offen  lds
  v_mfma_f32_16x16x32_bf16 v[108:111], v[232:235], v[204:207], v[108:111]
  v_mfma_f32_16x16x32_bf16 v[108:111], v[248:251], v[220:223], v[108:111]
  ds_read_b64_tr_b16 v[186:187], v22 offset:256
  ds_read_b64_tr_b16 v[188:189], v22 offset:512
  v_mfma_f32_16x16x32_bf16 v[112:115], v[236:239], v[192:195], v[112:115]
  v_mfma_f32_16x16x32_bf16 v[112:115], v[252:255], v[208:211], v[112:115]
  ds_read_b64_tr_b16 v[190:191], v22 offset:768
  s_add_u32 m0, s80, 19456
  s_nop 0
  buffer_load_dwordx4 v14, s[24:27], s69 offen  lds
  s_add_u32 s69, s69, s70
  s_cmp_eq_u32 s68, 1024
  s_cselect_b32 s68, 0, s68
  s_cselect_b32 s69, 0, s69
  v_mfma_f32_16x16x32_bf16 v[116:119], v[236:239], v[196:199], v[116:119]
  v_mfma_f32_16x16x32_bf16 v[116:119], v[252:255], v[212:215], v[116:119]
  v_mfma_f32_16x16x32_bf16 v[120:123], v[236:239], v[200:203], v[120:123]
  v_mfma_f32_16x16x32_bf16 v[120:123], v[252:255], v[216:219], v[120:123]
  v_mfma_f32_16x16x32_bf16 v[124:127], v[236:239], v[204:207], v[124:127]
  v_mfma_f32_16x16x32_bf16 v[124:127], v[252:255], v[220:223], v[124:127]
  s_waitcnt vmcnt(7) lgkmcnt(0)
  s_barrier
  v_mfma_f32_16x16x32_bf16 v[64:67], v[160:163], v[128:131], v[64:67]
  v_mfma_f32_16x16x32_bf16 v[64:67], v[176:179], v[144:147], v[64:67]
  v_add_u32 v15, 0xc000, v15
  v_add_u32 v16, 0xc000, v16
  v_add_u32 v19, 0xc000, v19
  v_add_u32 v20, 0xc000, v20
  v_add_u32 v21, 0xc000, v21
  v_add_u32 v22, 0xc000, v22
  ds_read_b128 v[192:195], v15 offset:0
  v_mfma_f32_16x16x32_bf16 v[68:71], v[160:163], v[132:135], v[68:71]
  v_mfma_f32_16x16x32_bf16 v[68:71], v[176:179], v[148:151], v[68:71]
  ds_read_b128 v[196:199], v15 offset:2048
  ds_read_b128 v[200:203], v15 offset:4096
  s_add_u32 m0, s79, 49152
  s_nop 0
  buffer_load_dwordx4 v9, s[16:19], s68 offen  lds
  v_mfma_f32_16x16x32_bf16 v[72:75], v[160:163], v[136:139], v[72:75]
  v_mfma_f32_16x16x32_bf16 v[72:75], v[176:179], v[152:155], v[72:75]
  ds_read_b128 v[204:207], v15 offset:6144
  ds_read_b128 v[208:211], v16 offset:0
  v_mfma_f32_16x16x32_bf16 v[76:79], v[160:163], v[140:143], v[76:79]
  v_mfma_f32_16x16x32_bf16 v[76:79], v[176:179], v[156:159], v[76:79]
  ds_read_b128 v[212:215], v16 offset:2048
  ds_read_b128 v[216:219], v16 offset:4096
  s_add_u32 m0, s79, 50176
  s_nop 0
  buffer_load_dwordx4 v10, s[16:19], s68 offen  lds
  v_mfma_f32_16x16x32_bf16 v[80:83], v[164:167], v[128:131], v[80:83]
  v_mfma_f32_16x16x32_bf16 v[80:83], v[180:183], v[144:147], v[80:83]
  ds_read_b128 v[220:223], v16 offset:6144
  ds_read_b64_tr_b16 v[224:225], v19 offset:0
  v_mfma_f32_16x16x32_bf16 v[84:87], v[164:167], v[132:135], v[84:87]
  v_mfma_f32_16x16x32_bf16 v[84:87], v[180:183], v[148:151], v[84:87]
  ds_read_b64_tr_b16 v[226:227], v19 offset:1792
  ds_read_b64_tr_b16 v[228:229], v19 offset:14336
  s_add_u32 m0, s80, 65536
  s_add_u32 s68, s68, 128
  buffer_load_dwordx4 v11, s[20:23], s69 offen  lds
  v_mfma_f32_16x16x32_bf16 v[88:91], v[164:167], v[136:139], v[88:91]
  v_mfma_f32_16x16x32_bf16 v[88:91], v[180:183], v[152:155], v[88:91]
  ds_read_b64_tr_b16 v[230:231], v19 offset:16128
  ds_read_b64_tr_b16 v[232:233], v21 offset:0
  v_mfma_f32_16x16x32_bf16 v[92:95], v[164:167], v[140:143], v[92:95]
  v_mfma_f32_16x16x32_bf16 v[92:95], v[180:183], v[156:159], v[92:95]
  ds_read_b64_tr_b16 v[234:235], v21 offset:256
  ds_read_b64_tr_b16 v[236:237], v21 offset:512
  v_mfma_f32_16x16x32_bf16 v[96:99], v[168:171], v[128:131], v[96:99]
  v_mfma_f32_16x16x32_bf16 v[96:99], v[184:187], v[144:147], v[96:99]
  ds_read_b64_tr_b16 v[238:239], v21 offset:768
  ds_read_b64_tr_b16 v[240:241], v20 offset:0
  s_add_u32 m0, s80, 66560
  s_nop 0
  buffer_load_dwordx4 v12, s[20:23], s69 offen  lds
  v_mfma_f32_16x16x32_bf16 v[100:103], v[168:171], v[132:135], v[100:103]
  v_mfma_f32_16x16x32_bf16 v[100:103], v[184:187], v[148:151], v[100:103]
  ds_read_b64_tr_b16 v[242:243], v20 offset:1792
  ds_read_b64_tr_b16 v[244:245], v20 offset:14336
  v_mfma_f32_16x16x32_bf16 v[104:107], v[168:171], v[136:139], v[104:107]
  v_mfma_f32_16x16x32_bf16 v[104:107], v[184:187], v[152:155], v[104:107]
  ds_read_b64_tr_b16 v[246:247], v20 offset:16128
  ds_read_b64_tr_b16 v[248:249], v22 offset:0
  s_add_u32 m0, s80, 67584
  s_nop 0
  buffer_load_dwordx4 v13, s[24:27], s69 offen  lds
  v_mfma_f32_16x16x32_bf16 v[108:111], v[168:171], v[140:143], v[108:111]
  v_mfma_f32_16x16x32_bf16 v[108:111], v[184:187], v[156:159], v[108:111]
  ds_read_b64_tr_b16 v[250:251], v22 offset:256
  ds_read_b64_tr_b16 v[252:253], v22 offset:512
  v_mfma_f32_16x16x32_bf16 v[112:115], v[172:175], v[128:131], v[112:115]
  v_mfma_f32_16x16x32_bf16 v[112:115], v[188:191], v[144:147], v[112:115]
  ds_read_b64_tr_b16 v[254:255], v22 offset:768
  s_add_u32 m0, s80, 68608
  s_nop 0
  buffer_load_dwordx4 v14, s[24:27], s69 offen  lds
  s_add_u32 s69, s69, s70
  s_cmp_eq_u32 s68, 1024
  s_cselect_b32 s68, 0, s68
  s_cselect_b32 s69, 0, s69
  v_mfma_f32_16x16x32_bf16 v[116:119], v[172:175], v[132:135], v[116:119]
  v_mfma_f32_16x16x32_bf16 v[116:119], v[188:191], v[148:151], v[116:119]
  v_mfma_f32_16x16x32_bf16 v[120:123], v[172:175], v[136:139], v[120:123]
  v_mfma_f32_16x16x32_bf16 v[120:123], v[188:191], v[152:155], v[120:123]
  v_mfma_f32_16x16x32_bf16 v[124:127], v[172:175], v[140:143], v[124:127]
  v_mfma_f32_16x16x32_bf16 v[124:127], v[188:191], v[156:159], v[124:127]
  s_waitcnt vmcnt(6) lgkmcnt(0)
  s_barrier
  v_lshlrev_b32 v6, 2, v1
  s_cmp_eq_u32 s4, 0
  s_cselect_b32 s33, 0, 0x7ff00000
  v_add_u32 v6, s33, v6
  s_nop 0
  buffer_load_dword v23, v6, s[12:15], 0 offen sc1
  v_mfma_f32_16x16x32_bf16 v[64:67], v[224:227], v[192:195], v[64:67]
  v_mfma_f32_16x16x32_bf16 v[64:67], v[240:243], v[208:211], v[64:67]
  v_add_u32 v15, 0xfffe8000, v15
  v_add_u32 v16, 0xfffe8000, v16
  v_add_u32 v19, 0xfffe8000, v19
  v_add_u32 v20, 0xfffe8000, v20
  v_add_u32 v21, 0xfffe8000, v21
  v_add_u32 v22, 0xfffe8000, v22
  ds_read_b128 v[128:131], v15 offset:0
  v_mfma_f32_16x16x32_bf16 v[68:71], v[224:227], v[196:199], v[68:71]
  v_mfma_f32_16x16x32_bf16 v[68:71], v[240:243], v[212:215], v[68:71]
  ds_read_b128 v[132:135], v15 offset:2048
  ds_read_b128 v[136:139], v15 offset:4096
  v_lshrrev_b32 v5, 2, v3
  v_and_b32 v6, 3, v3
  v_lshl_add_u32 v5, v5, 3, v6
  v_lshlrev_b32 v5, 1, v5
  v_mfma_f32_16x16x32_bf16 v[72:75], v[224:227], v[200:203], v[72:75]
  v_mfma_f32_16x16x32_bf16 v[72:75], v[240:243], v[216:219], v[72:75]
  ds_read_b128 v[140:143], v15 offset:6144
  ds_read_b128 v[144:147], v16 offset:0
  v_lshrrev_b32 v6, 1, v4
  v_lshlrev_b32 v6, 14, v6
  v_and_b32 v8, 1, v4
  v_lshl_add_u32 v6, v8, 12, v6
  v_mfma_f32_16x16x32_bf16 v[76:79], v[224:227], v[204:207], v[76:79]
  v_mfma_f32_16x16x32_bf16 v[76:79], v[240:243], v[220:223], v[76:79]
  ds_read_b128 v[148:151], v16 offset:2048
  ds_read_b128 v[152:155], v16 offset:4096
  v_add_u32 v8, v6, v5
  v_lshl_add_u32 v7, v4, 12, v5
  s_cmp_eq_u32 s78, 1
  s_cselect_b64 vcc, -1, 0
  v_cndmask_b32 v7, v7, v8, vcc
  v_mfma_f32_16x16x32_bf16 v[80:83], v[228:231], v[192:195], v[80:83]
  v_mfma_f32_16x16x32_bf16 v[80:83], v[244:247], v[208:211], v[80:83]
  ds_read_b128 v[156:159], v16 offset:6144
  ds_read_b64_tr_b16 v[160:161], v19 offset:0
  buffer_load_ushort v24, v7, s[60:63], s75 offen offset:0
  v_mfma_f32_16x16x32_bf16 v[84:87], v[228:231], v[196:199], v[84:87]
  v_mfma_f32_16x16x32_bf16 v[84:87], v[244:247], v[212:215], v[84:87]
  ds_read_b64_tr_b16 v[162:163], v19 offset:1792
  ds_read_b64_tr_b16 v[164:165], v19 offset:14336
  buffer_load_ushort v25, v7, s[60:63], s75 offen offset:1024
  v_mfma_f32_16x16x32_bf16 v[88:91], v[228:231], v[200:203], v[88:91]
  v_mfma_f32_16x16x32_bf16 v[88:91], v[244:247], v[216:219], v[88:91]
  ds_read_b64_tr_b16 v[166:167], v19 offset:16128
  ds_read_b64_tr_b16 v[168:169], v21 offset:0
  buffer_load_ushort v26, v7, s[60:63], s75 offen offset:2048
  v_mfma_f32_16x16x32_bf16 v[92:95], v[228:231], v[204:207], v[92:95]
  v_mfma_f32_16x16x32_bf16 v[92:95], v[244:247], v[220:223], v[92:95]
  ds_read_b64_tr_b16 v[170:171], v21 offset:256
  ds_read_b64_tr_b16 v[172:173], v21 offset:512
  buffer_load_ushort v27, v7, s[60:63], s75 offen offset:3072
  v_mfma_f32_16x16x32_bf16 v[96:99], v[232:235], v[192:195], v[96:99]
  v_mfma_f32_16x16x32_bf16 v[96:99], v[248:251], v[208:211], v[96:99]
  ds_read_b64_tr_b16 v[174:175], v21 offset:768
  ds_read_b64_tr_b16 v[176:177], v20 offset:0
  buffer_load_ushort v28, v7, s[60:63], s76 offen offset:0
  v_mfma_f32_16x16x32_bf16 v[100:103], v[232:235], v[196:199], v[100:103]
  v_mfma_f32_16x16x32_bf16 v[100:103], v[248:251], v[212:215], v[100:103]
  ds_read_b64_tr_b16 v[178:179], v20 offset:1792
  ds_read_b64_tr_b16 v[180:181], v20 offset:14336
  buffer_load_ushort v29, v7, s[60:63], s76 offen offset:1024
  v_mfma_f32_16x16x32_bf16 v[104:107], v[232:235], v[200:203], v[104:107]
  v_mfma_f32_16x16x32_bf16 v[104:107], v[248:251], v[216:219], v[104:107]
  ds_read_b64_tr_b16 v[182:183], v20 offset:16128
  ds_read_b64_tr_b16 v[184:185], v22 offset:0
  buffer_load_ushort v30, v7, s[60:63], s76 offen offset:2048
  v_mfma_f32_16x16x32_bf16 v[108:111], v[232:235], v[204:207], v[108:111]
  v_mfma_f32_16x16x32_bf16 v[108:111], v[248:251], v[220:223], v[108:111]
  ds_read_b64_tr_b16 v[186:187], v22 offset:256
  ds_read_b64_tr_b16 v[188:189], v22 offset:512
  buffer_load_ushort v31, v7, s[60:63], s76 offen offset:3072
  v_mfma_f32_16x16x32_bf16 v[112:115], v[236:239], v[192:195], v[112:115]
  v_mfma_f32_16x16x32_bf16 v[112:115], v[252:255], v[208:211], v[112:115]
  ds_read_b64_tr_b16 v[190:191], v22 offset:768
  buffer_load_ushort v32, v8, s[64:67], s77 offen
  v_mfma_f32_16x16x32_bf16 v[116:119], v[236:239], v[196:199], v[116:119]
  v_mfma_f32_16x16x32_bf16 v[116:119], v[252:255], v[212:215], v[116:119]
  buffer_load_ushort v33, v8, s[64:67], s77 offen offset:1024
  v_mfma_f32_16x16x32_bf16 v[120:123], v[236:239], v[200:203], v[120:123]
  v_mfma_f32_16x16x32_bf16 v[120:123], v[252:255], v[216:219], v[120:123]
  v_mfma_f32_16x16x32_bf16 v[124:127], v[236:239], v[204:207], v[124:127]
  v_mfma_f32_16x16x32_bf16 v[124:127], v[252:255], v[220:223], v[124:127]
  s_waitcnt vmcnt(10) lgkmcnt(0)
  s_cmp_eq_u32 s4, 0
  s_cbranch_scc0 recurrent_scan__grouped_kv_mqa__swiglu_ffn__prompt_kernel_B6_nochk
  v_lshlrev_b32 v6, 2, v1
  s_mov_b32 s71, 0
recurrent_scan__grouped_kv_mqa__swiglu_ffn__prompt_kernel_B6f_ck:
  v_lshrrev_b32 v5, 0, v23
  v_and_b32 v5, 0x01010101, v5
  v_cmp_ne_u32 vcc, 0x01010101, v5
  s_add_u32 s71, s71, 1
  s_nop 3
  s_cbranch_vccz recurrent_scan__grouped_kv_mqa__swiglu_ffn__prompt_kernel_B6f_ok
  s_cmp_ge_u32 s71, 20000
  s_cbranch_scc1 recurrent_scan__grouped_kv_mqa__swiglu_ffn__prompt_kernel_B6f_ok
  s_sleep 1
  buffer_load_dword v23, v6, s[12:15], 0 offen sc1
  s_waitcnt vmcnt(0)
  s_branch recurrent_scan__grouped_kv_mqa__swiglu_ffn__prompt_kernel_B6f_ck
recurrent_scan__grouped_kv_mqa__swiglu_ffn__prompt_kernel_B6f_ok:
recurrent_scan__grouped_kv_mqa__swiglu_ffn__prompt_kernel_B6_nochk:
  s_barrier
  v_mfma_f32_16x16x32_bf16 v[64:67], v[160:163], v[128:131], v[64:67]
  v_mfma_f32_16x16x32_bf16 v[64:67], v[176:179], v[144:147], v[64:67]
  v_add_u32 v15, 0xc000, v15
  v_add_u32 v16, 0xc000, v16
  v_add_u32 v19, 0xc000, v19
  v_add_u32 v20, 0xc000, v20
  v_add_u32 v21, 0xc000, v21
  v_add_u32 v22, 0xc000, v22
  ds_read_b128 v[192:195], v15 offset:0
  v_mfma_f32_16x16x32_bf16 v[68:71], v[160:163], v[132:135], v[68:71]
  v_mfma_f32_16x16x32_bf16 v[68:71], v[176:179], v[148:151], v[68:71]
  ds_read_b128 v[196:199], v15 offset:2048
  ds_read_b128 v[200:203], v15 offset:4096
  s_lshl_b32 s33, s6, 14
  s_lshl_b32 s34, s32, 8
  s_add_u32 s33, s33, s34
  s_add_u32 s75, s33, 20971520
  s_lshl_b32 s33, s5, 14
  s_lshl_b32 s34, s4, 7
  s_add_u32 s33, s33, s34
  s_add_u32 s76, s33, 22020096
  v_lshlrev_b32 v7, 10, v4
  v_lshl_add_u32 v8, v3, 3, v7
  v_lshl_add_u32 v7, v3, 4, v7
  buffer_load_dwordx4 v[48:51], v7, s[8:11], s75 offen sc1
  s_add_u32 s75, s75, 4096
  v_mfma_f32_16x16x32_bf16 v[72:75], v[160:163], v[136:139], v[72:75]
  v_mfma_f32_16x16x32_bf16 v[72:75], v[176:179], v[152:155], v[72:75]
  ds_read_b128 v[204:207], v15 offset:6144
  ds_read_b128 v[208:211], v16 offset:0
  buffer_load_dwordx4 v[52:55], v7, s[8:11], s75 offen sc1
  s_add_u32 s75, s75, 4096
  v_mfma_f32_16x16x32_bf16 v[76:79], v[160:163], v[140:143], v[76:79]
  v_mfma_f32_16x16x32_bf16 v[76:79], v[176:179], v[156:159], v[76:79]
  ds_read_b128 v[212:215], v16 offset:2048
  ds_read_b128 v[216:219], v16 offset:4096
  buffer_load_dwordx4 v[56:59], v7, s[8:11], s75 offen sc1
  s_add_u32 s75, s75, 4096
  v_mfma_f32_16x16x32_bf16 v[80:83], v[164:167], v[128:131], v[80:83]
  v_mfma_f32_16x16x32_bf16 v[80:83], v[180:183], v[144:147], v[80:83]
  ds_read_b128 v[220:223], v16 offset:6144
  ds_read_b64_tr_b16 v[224:225], v19 offset:0
  buffer_load_dwordx4 v[60:63], v7, s[8:11], s75 offen sc1
  s_add_u32 s75, s75, 4096
  v_mfma_f32_16x16x32_bf16 v[84:87], v[164:167], v[132:135], v[84:87]
  v_mfma_f32_16x16x32_bf16 v[84:87], v[180:183], v[148:151], v[84:87]
  ds_read_b64_tr_b16 v[226:227], v19 offset:1792
  ds_read_b64_tr_b16 v[228:229], v19 offset:14336
  buffer_load_dwordx2 v[40:41], v8, s[8:11], s76 offen sc1
  s_add_u32 s76, s76, 4096
  v_mfma_f32_16x16x32_bf16 v[88:91], v[164:167], v[136:139], v[88:91]
  v_mfma_f32_16x16x32_bf16 v[88:91], v[180:183], v[152:155], v[88:91]
  ds_read_b64_tr_b16 v[230:231], v19 offset:16128
  ds_read_b64_tr_b16 v[232:233], v21 offset:0
  buffer_load_dwordx2 v[42:43], v8, s[8:11], s76 offen sc1
  s_add_u32 s76, s76, 4096
  v_mfma_f32_16x16x32_bf16 v[92:95], v[164:167], v[140:143], v[92:95]
  v_mfma_f32_16x16x32_bf16 v[92:95], v[180:183], v[156:159], v[92:95]
  ds_read_b64_tr_b16 v[234:235], v21 offset:256
  ds_read_b64_tr_b16 v[236:237], v21 offset:512
  buffer_load_dwordx2 v[44:45], v8, s[8:11], s76 offen sc1
  s_add_u32 s76, s76, 4096
  v_mfma_f32_16x16x32_bf16 v[96:99], v[168:171], v[128:131], v[96:99]
  v_mfma_f32_16x16x32_bf16 v[96:99], v[184:187], v[144:147], v[96:99]
  ds_read_b64_tr_b16 v[238:239], v21 offset:768
  ds_read_b64_tr_b16 v[240:241], v20 offset:0
  buffer_load_dwordx2 v[46:47], v8, s[8:11], s76 offen sc1
  s_add_u32 s76, s76, 4096
  v_mfma_f32_16x16x32_bf16 v[100:103], v[168:171], v[132:135], v[100:103]
  v_mfma_f32_16x16x32_bf16 v[100:103], v[184:187], v[148:151], v[100:103]
  ds_read_b64_tr_b16 v[242:243], v20 offset:1792
  ds_read_b64_tr_b16 v[244:245], v20 offset:14336
  v_mfma_f32_16x16x32_bf16 v[104:107], v[168:171], v[136:139], v[104:107]
  v_mfma_f32_16x16x32_bf16 v[104:107], v[184:187], v[152:155], v[104:107]
  ds_read_b64_tr_b16 v[246:247], v20 offset:16128
  ds_read_b64_tr_b16 v[248:249], v22 offset:0
  v_mfma_f32_16x16x32_bf16 v[108:111], v[168:171], v[140:143], v[108:111]
  v_mfma_f32_16x16x32_bf16 v[108:111], v[184:187], v[156:159], v[108:111]
  ds_read_b64_tr_b16 v[250:251], v22 offset:256
  ds_read_b64_tr_b16 v[252:253], v22 offset:512
  v_mfma_f32_16x16x32_bf16 v[112:115], v[172:175], v[128:131], v[112:115]
  v_mfma_f32_16x16x32_bf16 v[112:115], v[188:191], v[144:147], v[112:115]
  ds_read_b64_tr_b16 v[254:255], v22 offset:768
  v_mfma_f32_16x16x32_bf16 v[116:119], v[172:175], v[132:135], v[116:119]
  v_mfma_f32_16x16x32_bf16 v[116:119], v[188:191], v[148:151], v[116:119]
  v_mfma_f32_16x16x32_bf16 v[120:123], v[172:175], v[136:139], v[120:123]
  v_mfma_f32_16x16x32_bf16 v[120:123], v[188:191], v[152:155], v[120:123]
  v_mfma_f32_16x16x32_bf16 v[124:127], v[172:175], v[140:143], v[124:127]
  v_mfma_f32_16x16x32_bf16 v[124:127], v[188:191], v[156:159], v[124:127]
  s_waitcnt vmcnt(8) lgkmcnt(0)
  s_barrier
  s_mov_b32 s33, 0x5040100
  v_perm_b32 v24, v25, v24, s33
  v_perm_b32 v25, v27, v26, s33
  v_perm_b32 v26, v29, v28, s33
  v_perm_b32 v27, v31, v30, s33
  v_perm_b32 v32, v33, v32, s33
  buffer_store_dwordx4 v[24:27], v2, s[8:11], s73 offen sc1
  buffer_store_dword v32, v2, s[8:11], s74 offen sc1
  s_lshl_b32 s81, s4, 10
  v_mfma_f32_16x16x32_bf16 v[64:67], v[224:227], v[192:195], v[64:67]
  v_mfma_f32_16x16x32_bf16 v[64:67], v[240:243], v[208:211], v[64:67]
  v_mfma_f32_16x16x32_bf16 v[68:71], v[224:227], v[196:199], v[68:71]
  v_mfma_f32_16x16x32_bf16 v[68:71], v[240:243], v[212:215], v[68:71]
  s_mov_b32 m0, s81
  s_add_u32 s35, s81, 2097152
  s_add_u32 s81, s81, 8192
  buffer_load_dwordx4 v2, s[8:11], s35 offen  lds
  s_waitcnt vmcnt(3)
  v_mfma_f32_16x16x32_bf16 v[72:75], v[224:227], v[200:203], v[72:75]
  v_mfma_f32_16x16x32_bf16 v[72:75], v[240:243], v[216:219], v[72:75]
  v_pk_add_f32 v[40:41], v[40:41], v[42:43]
  v_pk_add_f32 v[44:45], v[44:45], v[46:47]
  v_pk_add_f32 v[48:49], v[48:49], v[52:53]
  v_pk_add_f32 v[50:51], v[50:51], v[54:55]
  s_mov_b32 m0, s81
  s_add_u32 s35, s81, 2097152
  s_add_u32 s81, s81, 8192
  buffer_load_dwordx4 v2, s[8:11], s35 offen  lds
  s_and_b32 s69, s4, 3
  s_lshr_b32 s70, s4, 2
  s_lshl_b32 s33, s70, 15
  v_add_u32 v7, s33, v2
  v_mov_b32 v10, 0xdddddddd
  v_mfma_f32_16x16x32_bf16 v[76:79], v[224:227], v[204:207], v[76:79]
  v_mfma_f32_16x16x32_bf16 v[76:79], v[240:243], v[220:223], v[76:79]
  v_pk_add_f32 v[56:57], v[56:57], v[60:61]
  v_pk_add_f32 v[58:59], v[58:59], v[62:63]
  v_pk_add_f32 v[40:41], v[40:41], v[44:45]
  s_nop 0
  v_and_b32 v5, 15, v1
  v_lshlrev_b32 v5, 4, v5
  v_lshrrev_b32 v6, 5, v1
  v_lshl_add_u32 v5, v6, 8, v5
  s_lshl_b32 s33, s70, 15
  s_add_u32 s33, s33, 65536
  v_add_u32 v8, s33, v5
  v_mfma_f32_16x16x32_bf16 v[80:83], v[228:231], v[192:195], v[80:83]
  v_mfma_f32_16x16x32_bf16 v[80:83], v[244:247], v[208:211], v[80:83]
  v_pk_add_f32 v[48:49], v[48:49], v[56:57]
  v_pk_add_f32 v[50:51], v[50:51], v[58:59]
  v_mfma_f32_16x16x4_f32 v[44:47], v18, v40, 0
  v_mfma_f32_16x16x4_f32 v[52:55], v18, v41, 0
  s_mov_b32 m0, s81
  s_add_u32 s35, s81, 2097152
  s_add_u32 s81, s81, 8192
  buffer_load_dwordx4 v2, s[8:11], s35 offen  lds
  s_mov_b32 s36, 0x0000ffff
  s_mov_b32 s37, 0x0000ffff
  v_and_b32 v5, 31, v1
  v_cmp_eq_u32 vcc, 16, v5
  v_cmp_eq_u32 s[38:39], 20, v5
  v_mov_b32 v6, 0x3f803f80
  v_mov_b32 v9, v2
  s_nop 1
  s_or_b64 vcc, vcc, s[38:39]
  v_cndmask_b32 v28, 0, v6, vcc
  v_mfma_f32_16x16x32_bf16 v[84:87], v[228:231], v[196:199], v[84:87]
  v_mfma_f32_16x16x32_bf16 v[84:87], v[244:247], v[212:215], v[84:87]
  v_mfma_f32_16x16x4_f32 v[56:59], v49, v18, 0
  v_mfma_f32_16x16x4_f32 v[60:63], v50, v18, 0
  v_mov_b32 v29, v28
  v_mov_b32 v30, v28
  v_mov_b32 v31, v28
  v_mov_b32 v32, v28
  v_mfma_f32_16x16x32_bf16 v[88:91], v[228:231], v[200:203], v[88:91]
  v_mfma_f32_16x16x32_bf16 v[88:91], v[244:247], v[216:219], v[88:91]
  s_nop 4
  v_mul_f32 v40, 0xbb000000, v44
  v_mul_f32 v42, 0x3b000000, v52
  v_fma_f32 v42, -v40, v40, v42
  v_max_f32 v42, 0, v42
  s_mov_b32 m0, s81
  s_add_u32 s35, s81, 2097152
  s_add_u32 s81, s81, 8192
  buffer_load_dwordx4 v2, s[8:11], s35 offen  lds
  v_mov_b32 v33, v28
  v_mov_b32 v34, v28
  v_mov_b32 v35, v28
  v_mfma_f32_16x16x32_bf16 v[92:95], v[228:231], v[204:207], v[92:95]
  v_mfma_f32_16x16x32_bf16 v[92:95], v[244:247], v[220:223], v[92:95]
  v_add_f32 v42, 0x3727c5ac, v42
  v_rsq_f32 v41, v42
  v_mov_b32 v43, 0
  s_lshl_b32 s33, s4, 8
  s_add_u32 s33, s33, 131072
  v_lshlrev_b32 v5, 4, v3
  v_add_u32 v5, s33, v5
  s_lshl_b32 s33, s69, 11
  s_lshl_b32 s34, s70, 10
  s_add_u32 s34, s34, s33
  s_add_u32 s33, s34, 135168
  v_add_u32 v11, s33, v2
  s_xor_b32 s34, s34, 1024
  s_add_u32 s33, s34, 135168
  v_add_u32 v12, s33, v2
  v_mfma_f32_16x16x32_bf16 v[96:99], v[232:235], v[192:195], v[96:99]
  v_mfma_f32_16x16x32_bf16 v[96:99], v[248:251], v[208:211], v[96:99]
  v_mfma_f32_16x16x4_f32 v[52:55], v48, v18, 0
  v_mfma_f32_16x16x4_f32 v[44:47], v51, v18, 0
  s_mov_b64 exec, 0xffff
  ds_write_b128 v5, v[40:43]
  s_mov_b64 exec, -1
  s_mov_b32 m0, s81
  s_add_u32 s35, s81, 2097152
  s_add_u32 s81, s81, 8192
  buffer_load_dwordx4 v2, s[8:11], s35 offen  lds
  v_mov_b32 v24, 0
  v_mov_b32 v25, 0
  v_mov_b32 v26, 0
  v_mov_b32 v27, 0
  v_mfma_f32_16x16x32_bf16 v[100:103], v[232:235], v[196:199], v[100:103]
  v_mfma_f32_16x16x32_bf16 v[100:103], v[248:251], v[212:215], v[100:103]
  s_mov_b32 m0, s81
  s_add_u32 s35, s81, 2097152
  s_add_u32 s81, s81, 8192
  buffer_load_dwordx4 v2, s[8:11], s35 offen  lds
  s_mov_b32 s24, s94
  s_mov_b32 s25, s95
  s_mov_b32 s26, 2097152
  s_mov_b32 s27, 0x20000
  v_and_b32 v6, 15, v1
  v_lshlrev_b32 v6, 10, v6
  v_lshrrev_b32 v13, 4, v1
  v_lshl_add_u32 v6, v13, 4, v6
  s_lshl_b32 s33, s42, 2
  s_add_u32 s33, s33, s41
  s_lshl_b32 s33, s33, 14
  s_lshl_b32 s34, s43, 7
  s_add_u32 s33, s33, s34
  s_lshl_b32 s34, s40, 6
  s_add_u32 s33, s33, s34
  v_add_u32 v13, s33, v6
  v_mfma_f32_16x16x32_bf16 v[104:107], v[232:235], v[200:203], v[104:107]
  v_mfma_f32_16x16x32_bf16 v[104:107], v[248:251], v[216:219], v[104:107]
  s_lshl_b32 s33, s43, 16
  s_lshl_b32 s34, s4, 10
  s_add_u32 s33, s33, s34
  s_add_u32 s75, s33, 14680064
  s_cmp_eq_u32 s4, 0
  s_cbranch_scc0 recurrent_scan__grouped_kv_mqa__swiglu_ffn__prompt_kernel_B7_noinit
  v_mov_b32 v5, 155648
  v_mov_b32 v6, 0
  ds_write_b32 v5, v6
  ds_write_b32 v5, v6 offset:4
  ds_write_b32 v5, v6 offset:8
recurrent_scan__grouped_kv_mqa__swiglu_ffn__prompt_kernel_B7_noinit:
  v_mfma_f32_16x16x32_bf16 v[108:111], v[232:235], v[204:207], v[108:111]
  v_mfma_f32_16x16x32_bf16 v[108:111], v[248:251], v[220:223], v[108:111]
  s_mov_b32 m0, s81
  s_add_u32 s35, s81, 2097152
  s_add_u32 s81, s81, 8192
  buffer_load_dwordx4 v2, s[8:11], s35 offen  lds
  v_mfma_f32_16x16x32_bf16 v[112:115], v[236:239], v[192:195], v[112:115]
  v_mfma_f32_16x16x32_bf16 v[112:115], v[252:255], v[208:211], v[112:115]
  v_mfma_f32_16x16x32_bf16 v[116:119], v[236:239], v[196:199], v[116:119]
  v_mfma_f32_16x16x32_bf16 v[116:119], v[252:255], v[212:215], v[116:119]
  s_mov_b32 m0, s81
  s_add_u32 s35, s81, 2097152
  s_add_u32 s81, s81, 8192
  buffer_load_dwordx4 v2, s[8:11], s35 offen  lds
  v_mfma_f32_16x16x32_bf16 v[120:123], v[236:239], v[200:203], v[120:123]
  v_mfma_f32_16x16x32_bf16 v[120:123], v[252:255], v[216:219], v[120:123]
  v_mfma_f32_16x16x32_bf16 v[124:127], v[236:239], v[204:207], v[124:127]
  v_mfma_f32_16x16x32_bf16 v[124:127], v[252:255], v[220:223], v[124:127]
recurrent_scan__grouped_kv_mqa__swiglu_ffn__prompt_kernel_epi:
  s_mov_b32 m0, s81
  s_add_u32 s35, s81, 2097152
  s_add_u32 s81, s81, 8192
  buffer_load_dwordx4 v2, s[8:11], s35 offen  lds
  s_waitcnt lgkmcnt(0)
  s_barrier
  s_lshl_b32 s33, s7, 10
  s_add_u32 s33, s33, 131072
  v_lshlrev_b32 v129, 4, v3
  v_add_u32 v129, s33, v129
  ds_read_b128 v[136:139], v129 offset:0
  ds_read_b128 v[140:143], v129 offset:256
  ds_read_b128 v[144:147], v129 offset:512
  ds_read_b128 v[148:151], v129 offset:768
  s_mov_b32 m0, s81
  s_add_u32 s35, s81, 2097152
  s_add_u32 s81, s81, 8192
  buffer_load_dwordx4 v2, s[8:11], s35 offen  lds
  s_lshl_b32 s33, s5, 3
  s_lshl_b32 s34, s7, 2
  s_add_u32 s33, s33, s34
  s_mul_i32 s68, s33, 57344
  s_add_u32 s68, s68, 4194304
  s_waitcnt lgkmcnt(0)
  v_mul_f32 v216, 0xbfb8aa3b, v137
  v_mul_f32 v218, 0xbfb8aa3b, v141
  v_mul_f32 v220, 0xbfb8aa3b, v145
  v_mul_f32 v222, 0xbfb8aa3b, v149
  s_cmp_eq_u32 s32, 3
  s_cbranch_scc1 recurrent_scan__grouped_kv_mqa__swiglu_ffn__prompt_kernel_epiB
  s_mul_i32 s35, s6, 3
  s_add_u32 s35, s35, s32
  s_lshl_b32 s35, s35, 10
  s_add_u32 s68, s68, s35
  v_pk_fma_f32 v[196:197], v[136:137], v[52:53], v[64:65] op_sel_hi:[0,1,1]
  v_pk_fma_f32 v[198:199], v[136:137], v[54:55], v[66:67] op_sel_hi:[0,1,1]
  v_pk_mul_f32 v[204:205], v[196:197], v[216:217] op_sel_hi:[1,0]
  v_pk_mul_f32 v[206:207], v[198:199], v[216:217] op_sel_hi:[1,0]
  v_pk_fma_f32 v[200:201], v[136:137], v[56:57], v[80:81] op_sel_hi:[0,1,1]
  v_pk_fma_f32 v[202:203], v[136:137], v[58:59], v[82:83] op_sel_hi:[0,1,1]
  v_exp_f32 v204, v204
  v_exp_f32 v205, v205
  v_exp_f32 v206, v206
  v_exp_f32 v207, v207
  v_pk_mul_f32 v[196:197], v[196:197], v[200:201]
  v_pk_mul_f32 v[198:199], v[198:199], v[202:203]
  v_pk_fma_f32 v[204:205], v[204:205], v[138:139], v[138:139] op_sel_hi:[1,0,0]
  v_pk_fma_f32 v[206:207], v[206:207], v[138:139], v[138:139] op_sel_hi:[1,0,0]
  v_rcp_f32 v204, v204
  v_rcp_f32 v205, v205
  v_rcp_f32 v206, v206
  v_rcp_f32 v207, v207
  s_nop 0
  v_pk_mul_f32 v[196:197], v[196:197], v[204:205]
  v_pk_mul_f32 v[198:199], v[198:199], v[206:207]
  v_cvt_pk_bf16_f32 v208, v196, v197
  v_cvt_pk_bf16_f32 v209, v198, v199
  s_mov_b32 m0, s81
  s_add_u32 s35, s81, 2097152
  s_add_u32 s81, s81, 8192
  buffer_load_dwordx4 v2, s[8:11], s35 offen  lds
  s_mov_b32 m0, s81
  s_add_u32 s35, s81, 2097152
  s_add_u32 s81, s81, 8192
  buffer_load_dwordx4 v2, s[8:11], s35 offen  lds
  s_mov_b32 m0, s81
  s_add_u32 s35, s81, 2097152
  s_add_u32 s81, s81, 8192
  buffer_load_dwordx4 v2, s[8:11], s35 offen  lds
  v_pk_fma_f32 v[196:197], v[136:137], v[60:61], v[96:97] op_sel_hi:[0,1,1]
  v_pk_fma_f32 v[198:199], v[136:137], v[62:63], v[98:99] op_sel_hi:[0,1,1]
  v_pk_mul_f32 v[204:205], v[196:197], v[216:217] op_sel_hi:[1,0]
  v_pk_mul_f32 v[206:207], v[198:199], v[216:217] op_sel_hi:[1,0]
  v_pk_fma_f32 v[200:201], v[136:137], v[44:45], v[112:113] op_sel_hi:[0,1,1]
  v_pk_fma_f32 v[202:203], v[136:137], v[46:47], v[114:115] op_sel_hi:[0,1,1]
  v_exp_f32 v204, v204
  v_exp_f32 v205, v205
  v_exp_f32 v206, v206
  v_exp_f32 v207, v207
  v_pk_mul_f32 v[196:197], v[196:197], v[200:201]
  v_pk_mul_f32 v[198:199], v[198:199], v[202:203]
  v_pk_fma_f32 v[204:205], v[204:205], v[138:139], v[138:139] op_sel_hi:[1,0,0]
  v_pk_fma_f32 v[206:207], v[206:207], v[138:139], v[138:139] op_sel_hi:[1,0,0]
  v_rcp_f32 v204, v204
  v_rcp_f32 v205, v205
  v_rcp_f32 v206, v206
  v_rcp_f32 v207, v207
  s_nop 0
  v_pk_mul_f32 v[196:197], v[196:197], v[204:205]
  v_pk_mul_f32 v[198:199], v[198:199], v[206:207]
  v_cvt_pk_bf16_f32 v210, v196, v197
  v_cvt_pk_bf16_f32 v211, v198, v199
  s_mov_b32 m0, s81
  s_add_u32 s35, s81, 2097152
  s_add_u32 s81, s81, 8192
  buffer_load_dwordx4 v2, s[8:11], s35 offen  lds
  s_mov_b32 m0, s81
  s_add_u32 s35, s81, 2097152
  s_add_u32 s81, s81, 8192
  buffer_load_dwordx4 v2, s[8:11], s35 offen  lds
  s_mov_b32 m0, s81
  s_add_u32 s35, s81, 2097152
  s_add_u32 s81, s81, 8192
  buffer_load_dwordx4 v2, s[8:11], s35 offen  lds
  buffer_store_dwordx4 v[208:211], v2, s[8:11], s68 offen sc1
  s_add_u32 s68, s68, 57344
  v_pk_fma_f32 v[196:197], v[140:141], v[52:53], v[68:69] op_sel_hi:[0,1,1]
  v_pk_fma_f32 v[198:199], v[140:141], v[54:55], v[70:71] op_sel_hi:[0,1,1]
  v_pk_mul_f32 v[204:205], v[196:197], v[218:219] op_sel_hi:[1,0]
  v_pk_mul_f32 v[206:207], v[198:199], v[218:219] op_sel_hi:[1,0]
  v_pk_fma_f32 v[200:201], v[140:141], v[56:57], v[84:85] op_sel_hi:[0,1,1]
  v_pk_fma_f32 v[202:203], v[140:141], v[58:59], v[86:87] op_sel_hi:[0,1,1]
  v_exp_f32 v204, v204
  v_exp_f32 v205, v205
  v_exp_f32 v206, v206
  v_exp_f32 v207, v207
  v_pk_mul_f32 v[196:197], v[196:197], v[200:201]
  v_pk_mul_f32 v[198:199], v[198:199], v[202:203]
  v_pk_fma_f32 v[204:205], v[204:205], v[142:143], v[142:143] op_sel_hi:[1,0,0]
  v_pk_fma_f32 v[206:207], v[206:207], v[142:143], v[142:143] op_sel_hi:[1,0,0]
  v_rcp_f32 v204, v204
  v_rcp_f32 v205, v205
  v_rcp_f32 v206, v206
  v_rcp_f32 v207, v207
  s_nop 0
  v_pk_mul_f32 v[196:197], v[196:197], v[204:205]
  v_pk_mul_f32 v[198:199], v[198:199], v[206:207]
  v_cvt_pk_bf16_f32 v212, v196, v197
  v_cvt_pk_bf16_f32 v213, v198, v199
  v_pk_fma_f32 v[196:197], v[140:141], v[60:61], v[100:101] op_sel_hi:[0,1,1]
  v_pk_fma_f32 v[198:199], v[140:141], v[62:63], v[102:103] op_sel_hi:[0,1,1]
  v_pk_mul_f32 v[204:205], v[196:197], v[218:219] op_sel_hi:[1,0]
  v_pk_mul_f32 v[206:207], v[198:199], v[218:219] op_sel_hi:[1,0]
  v_pk_fma_f32 v[200:201], v[140:141], v[44:45], v[116:117] op_sel_hi:[0,1,1]
  v_pk_fma_f32 v[202:203], v[140:141], v[46:47], v[118:119] op_sel_hi:[0,1,1]
  v_exp_f32 v204, v204
  v_exp_f32 v205, v205
  v_exp_f32 v206, v206
  v_exp_f32 v207, v207
  v_pk_mul_f32 v[196:197], v[196:197], v[200:201]
  v_pk_mul_f32 v[198:199], v[198:199], v[202:203]
  v_pk_fma_f32 v[204:205], v[204:205], v[142:143], v[142:143] op_sel_hi:[1,0,0]
  v_pk_fma_f32 v[206:207], v[206:207], v[142:143], v[142:143] op_sel_hi:[1,0,0]
  v_rcp_f32 v204, v204
  v_rcp_f32 v205, v205
  v_rcp_f32 v206, v206
  v_rcp_f32 v207, v207
  s_nop 0
  v_pk_mul_f32 v[196:197], v[196:197], v[204:205]
  v_pk_mul_f32 v[198:199], v[198:199], v[206:207]
  v_cvt_pk_bf16_f32 v214, v196, v197
  v_cvt_pk_bf16_f32 v215, v198, v199
  buffer_store_dwordx4 v[212:215], v2, s[8:11], s68 offen sc1
  s_add_u32 s68, s68, 57344
  v_pk_fma_f32 v[196:197], v[144:145], v[52:53], v[72:73] op_sel_hi:[0,1,1]
  v_pk_fma_f32 v[198:199], v[144:145], v[54:55], v[74:75] op_sel_hi:[0,1,1]
  v_pk_mul_f32 v[204:205], v[196:197], v[220:221] op_sel_hi:[1,0]
  v_pk_mul_f32 v[206:207], v[198:199], v[220:221] op_sel_hi:[1,0]
  v_pk_fma_f32 v[200:201], v[144:145], v[56:57], v[88:89] op_sel_hi:[0,1,1]
  v_pk_fma_f32 v[202:203], v[144:145], v[58:59], v[90:91] op_sel_hi:[0,1,1]
  v_exp_f32 v204, v204
  v_exp_f32 v205, v205
  v_exp_f32 v206, v206
  v_exp_f32 v207, v207
  v_pk_mul_f32 v[196:197], v[196:197], v[200:201]
  v_pk_mul_f32 v[198:199], v[198:199], v[202:203]
  v_pk_fma_f32 v[204:205], v[204:205], v[146:147], v[146:147] op_sel_hi:[1,0,0]
  v_pk_fma_f32 v[206:207], v[206:207], v[146:147], v[146:147] op_sel_hi:[1,0,0]
  v_rcp_f32 v204, v204
  v_rcp_f32 v205, v205
  v_rcp_f32 v206, v206
  v_rcp_f32 v207, v207
  s_nop 0
  v_pk_mul_f32 v[196:197], v[196:197], v[204:205]
  v_pk_mul_f32 v[198:199], v[198:199], v[206:207]
  v_cvt_pk_bf16_f32 v208, v196, v197
  v_cvt_pk_bf16_f32 v209, v198, v199
  v_pk_fma_f32 v[196:197], v[144:145], v[60:61], v[104:105] op_sel_hi:[0,1,1]
  v_pk_fma_f32 v[198:199], v[144:145], v[62:63], v[106:107] op_sel_hi:[0,1,1]
  v_pk_mul_f32 v[204:205], v[196:197], v[220:221] op_sel_hi:[1,0]
  v_pk_mul_f32 v[206:207], v[198:199], v[220:221] op_sel_hi:[1,0]
  v_pk_fma_f32 v[200:201], v[144:145], v[44:45], v[120:121] op_sel_hi:[0,1,1]
  v_pk_fma_f32 v[202:203], v[144:145], v[46:47], v[122:123] op_sel_hi:[0,1,1]
  v_exp_f32 v204, v204
  v_exp_f32 v205, v205
  v_exp_f32 v206, v206
  v_exp_f32 v207, v207
  v_pk_mul_f32 v[196:197], v[196:197], v[200:201]
  v_pk_mul_f32 v[198:199], v[198:199], v[202:203]
  v_pk_fma_f32 v[204:205], v[204:205], v[146:147], v[146:147] op_sel_hi:[1,0,0]
  v_pk_fma_f32 v[206:207], v[206:207], v[146:147], v[146:147] op_sel_hi:[1,0,0]
  v_rcp_f32 v204, v204
  v_rcp_f32 v205, v205
  v_rcp_f32 v206, v206
  v_rcp_f32 v207, v207
  s_nop 0
  v_pk_mul_f32 v[196:197], v[196:197], v[204:205]
  v_pk_mul_f32 v[198:199], v[198:199], v[206:207]
  v_cvt_pk_bf16_f32 v210, v196, v197
  v_cvt_pk_bf16_f32 v211, v198, v199
  buffer_store_dwordx4 v[208:211], v2, s[8:11], s68 offen sc1
  s_add_u32 s68, s68, 57344
  v_pk_fma_f32 v[196:197], v[148:149], v[52:53], v[76:77] op_sel_hi:[0,1,1]
  v_pk_fma_f32 v[198:199], v[148:149], v[54:55], v[78:79] op_sel_hi:[0,1,1]
  v_pk_mul_f32 v[204:205], v[196:197], v[222:223] op_sel_hi:[1,0]
  v_pk_mul_f32 v[206:207], v[198:199], v[222:223] op_sel_hi:[1,0]
  v_pk_fma_f32 v[200:201], v[148:149], v[56:57], v[92:93] op_sel_hi:[0,1,1]
  v_pk_fma_f32 v[202:203], v[148:149], v[58:59], v[94:95] op_sel_hi:[0,1,1]
  v_exp_f32 v204, v204
  v_exp_f32 v205, v205
  v_exp_f32 v206, v206
  v_exp_f32 v207, v207
  v_pk_mul_f32 v[196:197], v[196:197], v[200:201]
  v_pk_mul_f32 v[198:199], v[198:199], v[202:203]
  v_pk_fma_f32 v[204:205], v[204:205], v[150:151], v[150:151] op_sel_hi:[1,0,0]
  v_pk_fma_f32 v[206:207], v[206:207], v[150:151], v[150:151] op_sel_hi:[1,0,0]
  v_rcp_f32 v204, v204
  v_rcp_f32 v205, v205
  v_rcp_f32 v206, v206
  v_rcp_f32 v207, v207
  s_nop 0
  v_pk_mul_f32 v[196:197], v[196:197], v[204:205]
  v_pk_mul_f32 v[198:199], v[198:199], v[206:207]
  v_cvt_pk_bf16_f32 v212, v196, v197
  v_cvt_pk_bf16_f32 v213, v198, v199
  v_pk_fma_f32 v[196:197], v[148:149], v[60:61], v[108:109] op_sel_hi:[0,1,1]
  v_pk_fma_f32 v[198:199], v[148:149], v[62:63], v[110:111] op_sel_hi:[0,1,1]
  v_pk_mul_f32 v[204:205], v[196:197], v[222:223] op_sel_hi:[1,0]
  v_pk_mul_f32 v[206:207], v[198:199], v[222:223] op_sel_hi:[1,0]
  v_pk_fma_f32 v[200:201], v[148:149], v[44:45], v[124:125] op_sel_hi:[0,1,1]
  v_pk_fma_f32 v[202:203], v[148:149], v[46:47], v[126:127] op_sel_hi:[0,1,1]
  v_exp_f32 v204, v204
  v_exp_f32 v205, v205
  v_exp_f32 v206, v206
  v_exp_f32 v207, v207
  v_pk_mul_f32 v[196:197], v[196:197], v[200:201]
  v_pk_mul_f32 v[198:199], v[198:199], v[202:203]
  v_pk_fma_f32 v[204:205], v[204:205], v[150:151], v[150:151] op_sel_hi:[1,0,0]
  v_pk_fma_f32 v[206:207], v[206:207], v[150:151], v[150:151] op_sel_hi:[1,0,0]
  v_rcp_f32 v204, v204
  v_rcp_f32 v205, v205
  v_rcp_f32 v206, v206
  v_rcp_f32 v207, v207
  s_nop 0
  v_pk_mul_f32 v[196:197], v[196:197], v[204:205]
  v_pk_mul_f32 v[198:199], v[198:199], v[206:207]
  v_cvt_pk_bf16_f32 v214, v196, v197
  v_cvt_pk_bf16_f32 v215, v198, v199
  buffer_store_dwordx4 v[212:215], v2, s[8:11], s68 offen sc1
  s_add_u32 s68, s68, 57344
  s_branch recurrent_scan__grouped_kv_mqa__swiglu_ffn__prompt_kernel_epi_done
recurrent_scan__grouped_kv_mqa__swiglu_ffn__prompt_kernel_epiB:
  v_lshrrev_b32 v128, 1, v4
  v_lshlrev_b32 v128, 9, v128
  v_lshl_add_u32 v128, v3, 4, v128
  v_and_b32 v129, 1, v4
  v_lshl_add_u32 v128, v129, 3, v128
  s_lshl_b32 s33, s7, 12
  s_add_u32 s33, s33, 135168
  v_add_u32 v193, s33, v128
  s_and_b32 s35, s6, 1
  s_lshl_b32 s35, s35, 3
  v_add_u32 v194, s35, v2
  s_lshr_b32 s35, s6, 1
  s_add_u32 s35, s35, 48
  s_lshl_b32 s35, s35, 10
  s_add_u32 s68, s68, s35
  v_mul_f32 v204, 0x3eb8aa3b, v137
  v_pk_fma_f32 v[196:197], v[136:137], v[60:61], v[96:97] op_sel_hi:[0,1,1]
  v_pk_fma_f32 v[198:199], v[136:137], v[62:63], v[98:99] op_sel_hi:[0,1,1]
  v_pk_mul_f32 v[196:197], v[196:197], v[204:205] op_sel_hi:[1,0]
  v_pk_mul_f32 v[198:199], v[198:199], v[204:205] op_sel_hi:[1,0]
  v_cvt_pk_bf16_f32 v208, v196, v197
  v_cvt_pk_bf16_f32 v209, v198, v199
  ds_write_b64 v193, v[208:209] offset:0
  s_mov_b32 m0, s81
  s_add_u32 s35, s81, 2097152
  s_add_u32 s81, s81, 8192
  buffer_load_dwordx4 v2, s[8:11], s35 offen  lds
  s_mov_b32 m0, s81
  s_add_u32 s35, s81, 2097152
  s_add_u32 s81, s81, 8192
  buffer_load_dwordx4 v2, s[8:11], s35 offen  lds
  s_mov_b32 m0, s81
  s_add_u32 s35, s81, 2097152
  s_add_u32 s81, s81, 8192
  buffer_load_dwordx4 v2, s[8:11], s35 offen  lds
  v_pk_fma_f32 v[196:197], v[136:137], v[44:45], v[112:113] op_sel_hi:[0,1,1]
  v_pk_fma_f32 v[198:199], v[136:137], v[46:47], v[114:115] op_sel_hi:[0,1,1]
  v_pk_mul_f32 v[196:197], v[196:197], v[204:205] op_sel_hi:[1,0]
  v_pk_mul_f32 v[198:199], v[198:199], v[204:205] op_sel_hi:[1,0]
  v_cvt_pk_bf16_f32 v210, v196, v197
  v_cvt_pk_bf16_f32 v211, v198, v199
  ds_write_b64 v193, v[210:211] offset:1024
  s_mov_b32 m0, s81
  s_add_u32 s35, s81, 2097152
  s_add_u32 s81, s81, 8192
  buffer_load_dwordx4 v2, s[8:11], s35 offen  lds
  s_mov_b32 m0, s81
  s_add_u32 s35, s81, 2097152
  s_add_u32 s81, s81, 8192
  buffer_load_dwordx4 v2, s[8:11], s35 offen  lds
  s_mov_b32 m0, s81
  s_add_u32 s35, s81, 2097152
  s_add_u32 s81, s81, 8192
  buffer_load_dwordx4 v2, s[8:11], s35 offen  lds
  v_mul_f32 v204, 0x3eb8aa3b, v141
  v_pk_fma_f32 v[196:197], v[140:141], v[60:61], v[100:101] op_sel_hi:[0,1,1]
  v_pk_fma_f32 v[198:199], v[140:141], v[62:63], v[102:103] op_sel_hi:[0,1,1]
  v_pk_mul_f32 v[196:197], v[196:197], v[204:205] op_sel_hi:[1,0]
  v_pk_mul_f32 v[198:199], v[198:199], v[204:205] op_sel_hi:[1,0]
  v_cvt_pk_bf16_f32 v212, v196, v197
  v_cvt_pk_bf16_f32 v213, v198, v199
  ds_write_b64 v193, v[212:213] offset:256
  v_pk_fma_f32 v[196:197], v[140:141], v[44:45], v[116:117] op_sel_hi:[0,1,1]
  v_pk_fma_f32 v[198:199], v[140:141], v[46:47], v[118:119] op_sel_hi:[0,1,1]
  v_pk_mul_f32 v[196:197], v[196:197], v[204:205] op_sel_hi:[1,0]
  v_pk_mul_f32 v[198:199], v[198:199], v[204:205] op_sel_hi:[1,0]
  v_cvt_pk_bf16_f32 v214, v196, v197
  v_cvt_pk_bf16_f32 v215, v198, v199
  ds_write_b64 v193, v[214:215] offset:1280
  v_mul_f32 v204, 0x3eb8aa3b, v145
  v_pk_fma_f32 v[196:197], v[144:145], v[60:61], v[104:105] op_sel_hi:[0,1,1]
  v_pk_fma_f32 v[198:199], v[144:145], v[62:63], v[106:107] op_sel_hi:[0,1,1]
  v_pk_mul_f32 v[196:197], v[196:197], v[204:205] op_sel_hi:[1,0]
  v_pk_mul_f32 v[198:199], v[198:199], v[204:205] op_sel_hi:[1,0]
  v_cvt_pk_bf16_f32 v208, v196, v197
  v_cvt_pk_bf16_f32 v209, v198, v199
  ds_write_b64 v193, v[208:209] offset:2048
  v_pk_fma_f32 v[196:197], v[144:145], v[44:45], v[120:121] op_sel_hi:[0,1,1]
  v_pk_fma_f32 v[198:199], v[144:145], v[46:47], v[122:123] op_sel_hi:[0,1,1]
  v_pk_mul_f32 v[196:197], v[196:197], v[204:205] op_sel_hi:[1,0]
  v_pk_mul_f32 v[198:199], v[198:199], v[204:205] op_sel_hi:[1,0]
  v_cvt_pk_bf16_f32 v210, v196, v197
  v_cvt_pk_bf16_f32 v211, v198, v199
  ds_write_b64 v193, v[210:211] offset:3072
  v_mul_f32 v204, 0x3eb8aa3b, v149
  v_pk_fma_f32 v[196:197], v[148:149], v[60:61], v[108:109] op_sel_hi:[0,1,1]
  v_pk_fma_f32 v[198:199], v[148:149], v[62:63], v[110:111] op_sel_hi:[0,1,1]
  v_pk_mul_f32 v[196:197], v[196:197], v[204:205] op_sel_hi:[1,0]
  v_pk_mul_f32 v[198:199], v[198:199], v[204:205] op_sel_hi:[1,0]
  v_cvt_pk_bf16_f32 v212, v196, v197
  v_cvt_pk_bf16_f32 v213, v198, v199
  ds_write_b64 v193, v[212:213] offset:2304
  v_pk_fma_f32 v[196:197], v[148:149], v[44:45], v[124:125] op_sel_hi:[0,1,1]
  v_pk_fma_f32 v[198:199], v[148:149], v[46:47], v[126:127] op_sel_hi:[0,1,1]
  v_pk_mul_f32 v[196:197], v[196:197], v[204:205] op_sel_hi:[1,0]
  v_pk_mul_f32 v[198:199], v[198:199], v[204:205] op_sel_hi:[1,0]
  v_cvt_pk_bf16_f32 v214, v196, v197
  v_cvt_pk_bf16_f32 v215, v198, v199
  ds_write_b64 v193, v[214:215] offset:3328
  v_pk_fma_f32 v[196:197], v[136:137], v[52:53], v[64:65] op_sel_hi:[0,1,1]
  v_pk_fma_f32 v[198:199], v[136:137], v[54:55], v[66:67] op_sel_hi:[0,1,1]
  v_pk_mul_f32 v[204:205], v[196:197], v[216:217] op_sel_hi:[1,0]
  v_pk_mul_f32 v[206:207], v[198:199], v[216:217] op_sel_hi:[1,0]
  v_pk_fma_f32 v[200:201], v[136:137], v[56:57], v[80:81] op_sel_hi:[0,1,1]
  v_pk_fma_f32 v[202:203], v[136:137], v[58:59], v[82:83] op_sel_hi:[0,1,1]
  v_exp_f32 v204, v204
  v_exp_f32 v205, v205
  v_exp_f32 v206, v206
  v_exp_f32 v207, v207
  v_pk_mul_f32 v[196:197], v[196:197], v[200:201]
  v_pk_mul_f32 v[198:199], v[198:199], v[202:203]
  v_pk_fma_f32 v[204:205], v[204:205], v[138:139], v[138:139] op_sel_hi:[1,0,0]
  v_pk_fma_f32 v[206:207], v[206:207], v[138:139], v[138:139] op_sel_hi:[1,0,0]
  v_rcp_f32 v204, v204
  v_rcp_f32 v205, v205
  v_rcp_f32 v206, v206
  v_rcp_f32 v207, v207
  s_nop 0
  v_pk_mul_f32 v[196:197], v[196:197], v[204:205]
  v_pk_mul_f32 v[198:199], v[198:199], v[206:207]
  v_cvt_pk_bf16_f32 v208, v196, v197
  v_cvt_pk_bf16_f32 v209, v198, v199
  buffer_store_dwordx2 v[208:209], v194, s[8:11], s68 offen sc1
  s_add_u32 s68, s68, 57344
  v_pk_fma_f32 v[196:197], v[140:141], v[52:53], v[68:69] op_sel_hi:[0,1,1]
  v_pk_fma_f32 v[198:199], v[140:141], v[54:55], v[70:71] op_sel_hi:[0,1,1]
  v_pk_mul_f32 v[204:205], v[196:197], v[218:219] op_sel_hi:[1,0]
  v_pk_mul_f32 v[206:207], v[198:199], v[218:219] op_sel_hi:[1,0]
  v_pk_fma_f32 v[200:201], v[140:141], v[56:57], v[84:85] op_sel_hi:[0,1,1]
  v_pk_fma_f32 v[202:203], v[140:141], v[58:59], v[86:87] op_sel_hi:[0,1,1]
  v_exp_f32 v204, v204
  v_exp_f32 v205, v205
  v_exp_f32 v206, v206
  v_exp_f32 v207, v207
  v_pk_mul_f32 v[196:197], v[196:197], v[200:201]
  v_pk_mul_f32 v[198:199], v[198:199], v[202:203]
  v_pk_fma_f32 v[204:205], v[204:205], v[142:143], v[142:143] op_sel_hi:[1,0,0]
  v_pk_fma_f32 v[206:207], v[206:207], v[142:143], v[142:143] op_sel_hi:[1,0,0]
  v_rcp_f32 v204, v204
  v_rcp_f32 v205, v205
  v_rcp_f32 v206, v206
  v_rcp_f32 v207, v207
  s_nop 0
  v_pk_mul_f32 v[196:197], v[196:197], v[204:205]
  v_pk_mul_f32 v[198:199], v[198:199], v[206:207]
  v_cvt_pk_bf16_f32 v212, v196, v197
  v_cvt_pk_bf16_f32 v213, v198, v199
  buffer_store_dwordx2 v[212:213], v194, s[8:11], s68 offen sc1
  s_add_u32 s68, s68, 57344
  v_pk_fma_f32 v[196:197], v[144:145], v[52:53], v[72:73] op_sel_hi:[0,1,1]
  v_pk_fma_f32 v[198:199], v[144:145], v[54:55], v[74:75] op_sel_hi:[0,1,1]
  v_pk_mul_f32 v[204:205], v[196:197], v[220:221] op_sel_hi:[1,0]
  v_pk_mul_f32 v[206:207], v[198:199], v[220:221] op_sel_hi:[1,0]
  v_pk_fma_f32 v[200:201], v[144:145], v[56:57], v[88:89] op_sel_hi:[0,1,1]
  v_pk_fma_f32 v[202:203], v[144:145], v[58:59], v[90:91] op_sel_hi:[0,1,1]
  v_exp_f32 v204, v204
  v_exp_f32 v205, v205
  v_exp_f32 v206, v206
  v_exp_f32 v207, v207
  v_pk_mul_f32 v[196:197], v[196:197], v[200:201]
  v_pk_mul_f32 v[198:199], v[198:199], v[202:203]
  v_pk_fma_f32 v[204:205], v[204:205], v[146:147], v[146:147] op_sel_hi:[1,0,0]
  v_pk_fma_f32 v[206:207], v[206:207], v[146:147], v[146:147] op_sel_hi:[1,0,0]
  v_rcp_f32 v204, v204
  v_rcp_f32 v205, v205
  v_rcp_f32 v206, v206
  v_rcp_f32 v207, v207
  s_nop 0
  v_pk_mul_f32 v[196:197], v[196:197], v[204:205]
  v_pk_mul_f32 v[198:199], v[198:199], v[206:207]
  v_cvt_pk_bf16_f32 v208, v196, v197
  v_cvt_pk_bf16_f32 v209, v198, v199
  buffer_store_dwordx2 v[208:209], v194, s[8:11], s68 offen sc1
  s_add_u32 s68, s68, 57344
  v_pk_fma_f32 v[196:197], v[148:149], v[52:53], v[76:77] op_sel_hi:[0,1,1]
  v_pk_fma_f32 v[198:199], v[148:149], v[54:55], v[78:79] op_sel_hi:[0,1,1]
  v_pk_mul_f32 v[204:205], v[196:197], v[222:223] op_sel_hi:[1,0]
  v_pk_mul_f32 v[206:207], v[198:199], v[222:223] op_sel_hi:[1,0]
  v_pk_fma_f32 v[200:201], v[148:149], v[56:57], v[92:93] op_sel_hi:[0,1,1]
  v_pk_fma_f32 v[202:203], v[148:149], v[58:59], v[94:95] op_sel_hi:[0,1,1]
  v_exp_f32 v204, v204
  v_exp_f32 v205, v205
  v_exp_f32 v206, v206
  v_exp_f32 v207, v207
  v_pk_mul_f32 v[196:197], v[196:197], v[200:201]
  v_pk_mul_f32 v[198:199], v[198:199], v[202:203]
  v_pk_fma_f32 v[204:205], v[204:205], v[150:151], v[150:151] op_sel_hi:[1,0,0]
  v_pk_fma_f32 v[206:207], v[206:207], v[150:151], v[150:151] op_sel_hi:[1,0,0]
  v_rcp_f32 v204, v204
  v_rcp_f32 v205, v205
  v_rcp_f32 v206, v206
  v_rcp_f32 v207, v207
  s_nop 0
  v_pk_mul_f32 v[196:197], v[196:197], v[204:205]
  v_pk_mul_f32 v[198:199], v[198:199], v[206:207]
  v_cvt_pk_bf16_f32 v212, v196, v197
  v_cvt_pk_bf16_f32 v213, v198, v199
  buffer_store_dwordx2 v[212:213], v194, s[8:11], s68 offen sc1
  s_add_u32 s68, s68, 57344
  s_branch recurrent_scan__grouped_kv_mqa__swiglu_ffn__prompt_kernel_epi_doneB
recurrent_scan__grouped_kv_mqa__swiglu_ffn__prompt_kernel_epi_done:
  s_mov_b32 s71, 0
  s_branch recurrent_scan__grouped_kv_mqa__swiglu_ffn__prompt_kernel_ainit
recurrent_scan__grouped_kv_mqa__swiglu_ffn__prompt_kernel_epi_doneB:
  s_mov_b32 s71, 1
recurrent_scan__grouped_kv_mqa__swiglu_ffn__prompt_kernel_ainit:
  v_mfma_f32_32x32x16_bf16 v[224:239], v[24:27], v[24:27], 0
  v_mfma_f32_32x32x16_bf16 v[240:255], v[24:27], v[24:27], 0
  v_mfma_f32_32x32x16_bf16 v[36:51], v[24:27], v[24:27], 0
  v_mfma_f32_32x32x16_bf16 v[68:83], v[24:27], v[24:27], 0
  v_mfma_f32_32x32x16_bf16 v[84:99], v[24:27], v[24:27], 0
  s_cmp_eq_u32 s70, 0
  s_cselect_b64 vcc, -1, 0
  s_cmp_eq_u32 s71, 0
  s_cbranch_scc0 recurrent_scan__grouped_kv_mqa__swiglu_ffn__prompt_kernel_e2b
  s_waitcnt vmcnt(4) lgkmcnt(0)
  s_branch recurrent_scan__grouped_kv_mqa__swiglu_ffn__prompt_kernel_e2
recurrent_scan__grouped_kv_mqa__swiglu_ffn__prompt_kernel_e2b:
  s_waitcnt vmcnt(4) lgkmcnt(0)
recurrent_scan__grouped_kv_mqa__swiglu_ffn__prompt_kernel_e2:
  s_barrier
  ds_read_b128 v[16:19], v11
  ds_read_b128 v[24:27], v7
  ds_read_b128 v[20:23], v12
  s_mov_b64 exec, s[36:37]
  ds_read_b128 v[28:31], v8 offset:0
  s_mov_b64 exec, -1
  s_waitcnt lgkmcnt(2)
  v_mfma_f32_32x32x16_bf16 v[52:67], v[24:27], v[16:19], 0
  s_cbranch_vccnz recurrent_scan__grouped_kv_mqa__swiglu_ffn__prompt_kernel_pA
  s_setprio 1
recurrent_scan__grouped_kv_mqa__swiglu_ffn__prompt_kernel_pA:
  s_mov_b32 s72, 0
  s_waitcnt lgkmcnt(0)
  s_nop 7
  s_nop 1
.p2align 3
recurrent_scan__grouped_kv_mqa__swiglu_ffn__prompt_kernel_l0:
  s_cbranch_vccz recurrent_scan__grouped_kv_mqa__swiglu_ffn__prompt_kernel_g0p0
  s_setprio 2
recurrent_scan__grouped_kv_mqa__swiglu_ffn__prompt_kernel_g0p0:
  v_exp_f32 v52, v52
  v_exp_f32 v53, v53
  v_exp_f32 v54, v54
  v_smfmac_f32_32x32x32_bf16 v[240:255], v[32:35], v[44:51], v10
  s_mov_b64 exec, s[36:37]
  ds_read_b128 v[32:35], v8 offset:512
  s_mov_b64 exec, -1
  v_exp_f32 v55, v55
  v_exp_f32 v56, v56
  v_exp_f32 v57, v57
  v_mfma_f32_32x32x16_bf16 v[36:51], v[24:27], v[20:23], 0
  ds_read_b128 v[24:27], v7 offset:1024
  v_exp_f32 v58, v58
  v_exp_f32 v59, v59
  v_exp_f32 v60, v60
  v_exp_f32 v61, v61
  s_waitcnt lgkmcnt(2)
  v_smfmac_f32_32x32x32_bf16 v[224:239], v[28:31], v[52:59], v10
  v_exp_f32 v62, v62
  v_exp_f32 v63, v63
  v_exp_f32 v64, v64
  v_exp_f32 v65, v65
  v_exp_f32 v66, v66
  v_exp_f32 v67, v67
  v_exp_f32 v36, v36
  v_exp_f32 v37, v37
  v_exp_f32 v38, v38
  s_waitcnt lgkmcnt(1)
  v_smfmac_f32_32x32x32_bf16 v[224:239], v[32:35], v[60:67], v10
  v_exp_f32 v39, v39
  v_exp_f32 v40, v40
  v_exp_f32 v41, v41
  s_waitcnt lgkmcnt(0)
  v_mfma_f32_32x32x16_bf16 v[52:67], v[24:27], v[16:19], 0
  v_exp_f32 v42, v42
  v_exp_f32 v43, v43
  v_exp_f32 v44, v44
  v_exp_f32 v45, v45
  v_smfmac_f32_32x32x32_bf16 v[240:255], v[28:31], v[36:43], v10
  s_mov_b64 exec, s[36:37]
  ds_read_b128 v[28:31], v8 offset:1024
  s_mov_b64 exec, -1
  v_exp_f32 v46, v46
  v_exp_f32 v47, v47
  v_exp_f32 v48, v48
  v_exp_f32 v49, v49
  v_exp_f32 v50, v50
  v_exp_f32 v51, v51
  v_exp_f32 v52, v52
  v_exp_f32 v53, v53
  v_exp_f32 v54, v54
  v_smfmac_f32_32x32x32_bf16 v[240:255], v[32:35], v[44:51], v10
  s_mov_b64 exec, s[36:37]
  ds_read_b128 v[32:35], v8 offset:1536
  s_mov_b64 exec, -1
  v_exp_f32 v55, v55
  v_exp_f32 v56, v56
  v_exp_f32 v57, v57
  v_mfma_f32_32x32x16_bf16 v[36:51], v[24:27], v[20:23], 0
  ds_read_b128 v[24:27], v7 offset:2048
  v_exp_f32 v58, v58
  v_exp_f32 v59, v59
  v_exp_f32 v60, v60
  v_exp_f32 v61, v61
  s_waitcnt lgkmcnt(2)
  v_smfmac_f32_32x32x32_bf16 v[224:239], v[28:31], v[52:59], v10
  v_exp_f32 v62, v62
  v_exp_f32 v63, v63
  v_exp_f32 v64, v64
  v_exp_f32 v65, v65
  v_exp_f32 v66, v66
  v_exp_f32 v67, v67
  v_exp_f32 v36, v36
  v_exp_f32 v37, v37
  v_exp_f32 v38, v38
  s_waitcnt lgkmcnt(1)
  v_smfmac_f32_32x32x32_bf16 v[224:239], v[32:35], v[60:67], v10
  v_exp_f32 v39, v39
  v_exp_f32 v40, v40
  v_exp_f32 v41, v41
  s_waitcnt lgkmcnt(0)
  v_mfma_f32_32x32x16_bf16 v[52:67], v[24:27], v[16:19], 0
  v_exp_f32 v42, v42
  v_exp_f32 v43, v43
  v_exp_f32 v44, v44
  v_exp_f32 v45, v45
  v_smfmac_f32_32x32x32_bf16 v[240:255], v[28:31], v[36:43], v10
  s_mov_b64 exec, s[36:37]
  ds_read_b128 v[28:31], v8 offset:2048
  s_mov_b64 exec, -1
  v_exp_f32 v46, v46
  v_exp_f32 v47, v47
  v_exp_f32 v48, v48
  v_exp_f32 v49, v49
  v_exp_f32 v50, v50
  v_exp_f32 v51, v51
  v_exp_f32 v52, v52
  v_exp_f32 v53, v53
  v_exp_f32 v54, v54
  v_smfmac_f32_32x32x32_bf16 v[240:255], v[32:35], v[44:51], v10
  s_mov_b64 exec, s[36:37]
  ds_read_b128 v[32:35], v8 offset:2560
  s_mov_b64 exec, -1
  v_exp_f32 v55, v55
  v_exp_f32 v56, v56
  v_exp_f32 v57, v57
  v_mfma_f32_32x32x16_bf16 v[36:51], v[24:27], v[20:23], 0
  ds_read_b128 v[24:27], v7 offset:3072
  v_exp_f32 v58, v58
  v_exp_f32 v59, v59
  v_exp_f32 v60, v60
  v_exp_f32 v61, v61
  s_waitcnt lgkmcnt(2)
  v_smfmac_f32_32x32x32_bf16 v[224:239], v[28:31], v[52:59], v10
  v_exp_f32 v62, v62
  v_exp_f32 v63, v63
  v_exp_f32 v64, v64
  v_exp_f32 v65, v65
  v_exp_f32 v66, v66
  v_exp_f32 v67, v67
  v_exp_f32 v36, v36
  v_exp_f32 v37, v37
  v_exp_f32 v38, v38
  s_waitcnt lgkmcnt(1)
  v_smfmac_f32_32x32x32_bf16 v[224:239], v[32:35], v[60:67], v10
  v_exp_f32 v39, v39
  v_exp_f32 v40, v40
  v_exp_f32 v41, v41
  s_waitcnt lgkmcnt(0)
  v_mfma_f32_32x32x16_bf16 v[52:67], v[24:27], v[16:19], 0
  v_exp_f32 v42, v42
  v_exp_f32 v43, v43
  v_exp_f32 v44, v44
  v_exp_f32 v45, v45
  v_smfmac_f32_32x32x32_bf16 v[240:255], v[28:31], v[36:43], v10
  s_mov_b64 exec, s[36:37]
  ds_read_b128 v[28:31], v8 offset:3072
  s_mov_b64 exec, -1
  v_exp_f32 v46, v46
  v_exp_f32 v47, v47
  v_exp_f32 v48, v48
  v_exp_f32 v49, v49
  v_exp_f32 v50, v50
  v_exp_f32 v51, v51
  s_cbranch_vccz recurrent_scan__grouped_kv_mqa__swiglu_ffn__prompt_kernel_g0p1
  s_setprio 0
recurrent_scan__grouped_kv_mqa__swiglu_ffn__prompt_kernel_g0p1:
  v_exp_f32 v52, v52
  v_exp_f32 v53, v53
  v_exp_f32 v54, v54
  v_smfmac_f32_32x32x32_bf16 v[240:255], v[32:35], v[44:51], v10
  s_mov_b64 exec, s[36:37]
  ds_read_b128 v[32:35], v8 offset:3584
  s_mov_b64 exec, -1
  v_exp_f32 v55, v55
  v_exp_f32 v56, v56
  v_exp_f32 v57, v57
  v_mfma_f32_32x32x16_bf16 v[36:51], v[24:27], v[20:23], 0
  ds_read_b128 v[24:27], v7 offset:4096
  v_exp_f32 v58, v58
  v_exp_f32 v59, v59
  v_exp_f32 v60, v60
  v_exp_f32 v61, v61
  s_waitcnt lgkmcnt(2)
  v_smfmac_f32_32x32x32_bf16 v[224:239], v[28:31], v[52:59], v10
  v_exp_f32 v62, v62
  v_exp_f32 v63, v63
  v_exp_f32 v64, v64
  v_exp_f32 v65, v65
  v_exp_f32 v66, v66
  v_exp_f32 v67, v67
  v_exp_f32 v36, v36
  v_exp_f32 v37, v37
  v_exp_f32 v38, v38
  s_waitcnt lgkmcnt(1)
  v_smfmac_f32_32x32x32_bf16 v[224:239], v[32:35], v[60:67], v10
  v_exp_f32 v39, v39
  v_exp_f32 v40, v40
  v_exp_f32 v41, v41
  s_waitcnt lgkmcnt(0)
  v_mfma_f32_32x32x16_bf16 v[52:67], v[24:27], v[16:19], 0
  v_exp_f32 v42, v42
  v_exp_f32 v43, v43
  v_exp_f32 v44, v44
  v_exp_f32 v45, v45
  v_smfmac_f32_32x32x32_bf16 v[240:255], v[28:31], v[36:43], v10
  s_mov_b64 exec, s[36:37]
  ds_read_b128 v[28:31], v8 offset:4096
  s_mov_b64 exec, -1
  v_exp_f32 v46, v46
  v_exp_f32 v47, v47
  v_exp_f32 v48, v48
  v_exp_f32 v49, v49
  v_exp_f32 v50, v50
  v_exp_f32 v51, v51
  v_add_u32 v7, 4096, v7
  v_add_u32 v8, 4096, v8
  s_setprio 3
  s_cmp_eq_u32 s72, 0
  s_cbranch_scc0 recurrent_scan__grouped_kv_mqa__swiglu_ffn__prompt_kernel_h1
  s_waitcnt vmcnt(0)
  v_mov_b32 v5, 155652
  v_mov_b32 v6, 1
  s_mov_b64 exec, 1
  ds_add_rtn_u32 v6, v5, v6
  s_mov_b64 exec, -1
  s_waitcnt lgkmcnt(0)
  v_readfirstlane_b32 s33, v6
  s_nop 3
  s_cmp_eq_u32 s33, 7
  s_cbranch_scc0 recurrent_scan__grouped_kv_mqa__swiglu_ffn__prompt_kernel_h3
  s_lshl_b32 s33, s5, 4
  s_add_u32 s33, s33, s6
  s_and_b32 s34, s33, 3
  s_lshl_b32 s34, s34, 3
  s_lshl_b32 s34, 2, s34
  s_and_b32 s33, s33, 0xfc
  v_mov_b32 v5, s34
  v_mov_b32 v6, s33
  s_mov_b64 exec, 1
  buffer_atomic_or v5, v6, s[12:15], 0 offen sc1
  s_mov_b64 exec, -1
  s_branch recurrent_scan__grouped_kv_mqa__swiglu_ffn__prompt_kernel_h3
recurrent_scan__grouped_kv_mqa__swiglu_ffn__prompt_kernel_h1:
  s_cmp_eq_u32 s72, 1
  s_cbranch_scc0 recurrent_scan__grouped_kv_mqa__swiglu_ffn__prompt_kernel_h2
  v_lshlrev_b32 v12, 2, v1
  s_cmp_eq_u32 s4, 0
  s_cbranch_scc0 recurrent_scan__grouped_kv_mqa__swiglu_ffn__prompt_kernel_h3
  buffer_load_dword v11, v12, s[12:15], 0 offen sc1
  s_branch recurrent_scan__grouped_kv_mqa__swiglu_ffn__prompt_kernel_h3
recurrent_scan__grouped_kv_mqa__swiglu_ffn__prompt_kernel_h2:
  s_cmp_eq_u32 s72, 2
  s_cbranch_scc0 recurrent_scan__grouped_kv_mqa__swiglu_ffn__prompt_kernel_h3
  v_mov_b32 v6, 155648
  s_cmp_eq_u32 s4, 0
  s_cbranch_scc0 recurrent_scan__grouped_kv_mqa__swiglu_ffn__prompt_kernel_hw
  s_waitcnt vmcnt(0)
  s_mov_b32 s33, 0
recurrent_scan__grouped_kv_mqa__swiglu_ffn__prompt_kernel_h_ck:
  v_lshrrev_b32 v5, 1, v11
  v_and_b32 v5, 0x01010101, v5
  v_cmp_ne_u32 vcc, 0x01010101, v5
  s_add_u32 s33, s33, 1
  s_nop 3
  s_cbranch_vccz recurrent_scan__grouped_kv_mqa__swiglu_ffn__prompt_kernel_h_ok
  s_cmp_ge_u32 s33, 20000
  s_cbranch_scc1 recurrent_scan__grouped_kv_mqa__swiglu_ffn__prompt_kernel_h_ok
  s_sleep 1
  buffer_load_dword v11, v12, s[12:15], 0 offen sc1
  s_waitcnt vmcnt(0)
  s_branch recurrent_scan__grouped_kv_mqa__swiglu_ffn__prompt_kernel_h_ck
recurrent_scan__grouped_kv_mqa__swiglu_ffn__prompt_kernel_h_ok:
  v_mov_b32 v5, 1
  ds_write_b32 v6, v5 offset:8
  s_branch recurrent_scan__grouped_kv_mqa__swiglu_ffn__prompt_kernel_hgo
recurrent_scan__grouped_kv_mqa__swiglu_ffn__prompt_kernel_hw:
  s_mov_b32 s34, 0
recurrent_scan__grouped_kv_mqa__swiglu_ffn__prompt_kernel_hw2:
  ds_read_b32 v5, v6 offset:8
  s_add_u32 s34, s34, 1
  s_waitcnt lgkmcnt(0)
  v_readfirstlane_b32 s33, v5
  s_cmp_ge_u32 s34, 1280000
  s_cbranch_scc1 recurrent_scan__grouped_kv_mqa__swiglu_ffn__prompt_kernel_hgo
  s_nop 1
  s_cmp_eq_u32 s33, 0
  s_cbranch_scc0 recurrent_scan__grouped_kv_mqa__swiglu_ffn__prompt_kernel_hgo
  s_sleep 1
  s_branch recurrent_scan__grouped_kv_mqa__swiglu_ffn__prompt_kernel_hw2
recurrent_scan__grouped_kv_mqa__swiglu_ffn__prompt_kernel_hgo:
  s_cmp_eq_u32 s70, 0
  s_cselect_b64 vcc, -1, 0
recurrent_scan__grouped_kv_mqa__swiglu_ffn__prompt_kernel_h3:
  s_cbranch_vccnz recurrent_scan__grouped_kv_mqa__swiglu_ffn__prompt_kernel_h4
  s_setprio 1
recurrent_scan__grouped_kv_mqa__swiglu_ffn__prompt_kernel_h4:
  s_add_u32 s72, s72, 1
  s_cmp_lt_u32 s72, 3
  s_cbranch_scc1 recurrent_scan__grouped_kv_mqa__swiglu_ffn__prompt_kernel_l0
  s_mov_b32 s72, 0
  s_cbranch_vccz recurrent_scan__grouped_kv_mqa__swiglu_ffn__prompt_kernel_g0pp0
  s_setprio 2
recurrent_scan__grouped_kv_mqa__swiglu_ffn__prompt_kernel_g0pp0:
  v_exp_f32 v52, v52
  v_exp_f32 v53, v53
  v_exp_f32 v54, v54
  v_smfmac_f32_32x32x32_bf16 v[240:255], v[32:35], v[44:51], v10
  s_mov_b64 exec, s[36:37]
  ds_read_b128 v[32:35], v8 offset:512
  s_mov_b64 exec, -1
  v_exp_f32 v55, v55
  buffer_load_dwordx4 v[100:103], v9, s[8:11], s48 offen sc1
  buffer_load_dwordx4 v[104:107], v9, s[8:11], s49 offen sc1
  buffer_load_dwordx4 v[108:111], v9, s[8:11], s44 offen sc1
  v_exp_f32 v56, v56
  v_exp_f32 v57, v57
  v_mfma_f32_32x32x16_bf16 v[36:51], v[24:27], v[20:23], 0
  ds_read_b128 v[24:27], v7 offset:1024
  v_exp_f32 v58, v58
  v_exp_f32 v59, v59
  v_exp_f32 v60, v60
  v_exp_f32 v61, v61
  s_waitcnt lgkmcnt(2)
  v_smfmac_f32_32x32x32_bf16 v[224:239], v[28:31], v[52:59], v10
  v_exp_f32 v62, v62
  v_exp_f32 v63, v63
  v_exp_f32 v64, v64
  v_exp_f32 v65, v65
  v_exp_f32 v66, v66
  v_exp_f32 v67, v67
  v_exp_f32 v36, v36
  v_exp_f32 v37, v37
  v_exp_f32 v38, v38
  s_waitcnt lgkmcnt(1)
  v_smfmac_f32_32x32x32_bf16 v[224:239], v[32:35], v[60:67], v10
  v_exp_f32 v39, v39
  buffer_load_dwordx4 v[112:115], v9, s[8:11], s45 offen sc1
  buffer_load_dwordx4 v[116:119], v9, s[8:11], s46 offen sc1
  buffer_load_dwordx4 v[120:123], v9, s[8:11], s47 offen sc1
  v_add_u32 v9, 1024, v9
  v_exp_f32 v40, v40
  v_exp_f32 v41, v41
  s_waitcnt lgkmcnt(0)
  v_mfma_f32_32x32x16_bf16 v[52:67], v[24:27], v[16:19], 0
  v_exp_f32 v42, v42
  v_exp_f32 v43, v43
  v_exp_f32 v44, v44
  v_exp_f32 v45, v45
  v_smfmac_f32_32x32x32_bf16 v[240:255], v[28:31], v[36:43], v10
  s_mov_b64 exec, s[36:37]
  ds_read_b128 v[28:31], v8 offset:1024
  s_mov_b64 exec, -1
  v_exp_f32 v46, v46
  v_exp_f32 v47, v47
  v_exp_f32 v48, v48
  v_exp_f32 v49, v49
  v_exp_f32 v50, v50
  v_exp_f32 v51, v51
  v_exp_f32 v52, v52
  v_exp_f32 v53, v53
  v_exp_f32 v54, v54
  v_smfmac_f32_32x32x32_bf16 v[240:255], v[32:35], v[44:51], v10
  s_mov_b64 exec, s[36:37]
  ds_read_b128 v[32:35], v8 offset:1536
  s_mov_b64 exec, -1
  v_exp_f32 v55, v55
  buffer_load_dwordx4 v[124:127], v9, s[8:11], s48 offen sc1
  buffer_load_dwordx4 v[128:131], v9, s[8:11], s49 offen sc1
  buffer_load_dwordx4 v[132:135], v9, s[8:11], s44 offen sc1
  v_exp_f32 v56, v56
  v_exp_f32 v57, v57
  v_mfma_f32_32x32x16_bf16 v[36:51], v[24:27], v[20:23], 0
  ds_read_b128 v[24:27], v7 offset:2048
  v_exp_f32 v58, v58
  v_exp_f32 v59, v59
  v_exp_f32 v60, v60
  v_exp_f32 v61, v61
  s_waitcnt lgkmcnt(2)
  v_smfmac_f32_32x32x32_bf16 v[224:239], v[28:31], v[52:59], v10
  v_exp_f32 v62, v62
  v_exp_f32 v63, v63
  v_exp_f32 v64, v64
  v_exp_f32 v65, v65
  v_exp_f32 v66, v66
  v_exp_f32 v67, v67
  v_exp_f32 v36, v36
  v_exp_f32 v37, v37
  v_exp_f32 v38, v38
  s_waitcnt lgkmcnt(1)
  v_smfmac_f32_32x32x32_bf16 v[224:239], v[32:35], v[60:67], v10
  v_exp_f32 v39, v39
  buffer_load_dwordx4 v[136:139], v9, s[8:11], s45 offen sc1
  buffer_load_dwordx4 v[140:143], v9, s[8:11], s46 offen sc1
  buffer_load_dwordx4 v[144:147], v9, s[8:11], s47 offen sc1
  v_add_u32 v9, 1024, v9
  v_exp_f32 v40, v40
  v_exp_f32 v41, v41
  s_waitcnt lgkmcnt(0)
  v_mfma_f32_32x32x16_bf16 v[52:67], v[24:27], v[16:19], 0
  v_exp_f32 v42, v42
  v_exp_f32 v43, v43
  v_exp_f32 v44, v44
  v_exp_f32 v45, v45
  v_smfmac_f32_32x32x32_bf16 v[240:255], v[28:31], v[36:43], v10
  s_mov_b64 exec, s[36:37]
  ds_read_b128 v[28:31], v8 offset:2048
  s_mov_b64 exec, -1
  v_exp_f32 v46, v46
  v_exp_f32 v47, v47
  v_exp_f32 v48, v48
  v_exp_f32 v49, v49
  v_exp_f32 v50, v50
  v_exp_f32 v51, v51
  v_exp_f32 v52, v52
  v_exp_f32 v53, v53
  v_exp_f32 v54, v54
  v_smfmac_f32_32x32x32_bf16 v[240:255], v[32:35], v[44:51], v10
  s_mov_b64 exec, s[36:37]
  ds_read_b128 v[32:35], v8 offset:2560
  s_mov_b64 exec, -1
  v_exp_f32 v55, v55
  buffer_load_dwordx4 v[148:151], v9, s[8:11], s48 offen sc1
  buffer_load_dwordx4 v[152:155], v9, s[8:11], s49 offen sc1
  buffer_load_dwordx4 v[156:159], v9, s[8:11], s44 offen sc1
  v_exp_f32 v56, v56
  v_exp_f32 v57, v57
  v_mfma_f32_32x32x16_bf16 v[36:51], v[24:27], v[20:23], 0
  ds_read_b128 v[24:27], v7 offset:3072
  v_exp_f32 v58, v58
  v_exp_f32 v59, v59
  v_exp_f32 v60, v60
  v_exp_f32 v61, v61
  s_waitcnt lgkmcnt(2)
  v_smfmac_f32_32x32x32_bf16 v[224:239], v[28:31], v[52:59], v10
  v_exp_f32 v62, v62
  v_exp_f32 v63, v63
  v_exp_f32 v64, v64
  v_exp_f32 v65, v65
  v_exp_f32 v66, v66
  v_exp_f32 v67, v67
  v_exp_f32 v36, v36
  v_exp_f32 v37, v37
  v_exp_f32 v38, v38
  s_waitcnt lgkmcnt(1)
  v_smfmac_f32_32x32x32_bf16 v[224:239], v[32:35], v[60:67], v10
  v_exp_f32 v39, v39
  buffer_load_dwordx4 v[160:163], v9, s[8:11], s45 offen sc1
  buffer_load_dwordx4 v[164:167], v9, s[8:11], s46 offen sc1
  buffer_load_dwordx4 v[168:171], v9, s[8:11], s47 offen sc1
  v_add_u32 v9, 1024, v9
  v_exp_f32 v40, v40
  v_exp_f32 v41, v41
  s_waitcnt lgkmcnt(0)
  v_mfma_f32_32x32x16_bf16 v[52:67], v[24:27], v[16:19], 0
  v_exp_f32 v42, v42
  v_exp_f32 v43, v43
  v_exp_f32 v44, v44
  v_exp_f32 v45, v45
  v_smfmac_f32_32x32x32_bf16 v[240:255], v[28:31], v[36:43], v10
  s_mov_b64 exec, s[36:37]
  ds_read_b128 v[28:31], v8 offset:3072
  s_mov_b64 exec, -1
  v_exp_f32 v46, v46
  v_exp_f32 v47, v47
  v_exp_f32 v48, v48
  v_exp_f32 v49, v49
  v_exp_f32 v50, v50
  v_exp_f32 v51, v51
  s_cbranch_vccz recurrent_scan__grouped_kv_mqa__swiglu_ffn__prompt_kernel_g0pp1
  s_setprio 0
recurrent_scan__grouped_kv_mqa__swiglu_ffn__prompt_kernel_g0pp1:
  v_exp_f32 v52, v52
  v_exp_f32 v53, v53
  v_exp_f32 v54, v54
  v_smfmac_f32_32x32x32_bf16 v[240:255], v[32:35], v[44:51], v10
  s_mov_b64 exec, s[36:37]
  ds_read_b128 v[32:35], v8 offset:3584
  s_mov_b64 exec, -1
  v_exp_f32 v55, v55
  v_exp_f32 v56, v56
  v_exp_f32 v57, v57
  v_mfma_f32_32x32x16_bf16 v[36:51], v[24:27], v[20:23], 0
  ds_read_b128 v[24:27], v7 offset:4096
  v_exp_f32 v58, v58
  v_exp_f32 v59, v59
  v_exp_f32 v60, v60
  v_exp_f32 v61, v61
  s_waitcnt lgkmcnt(2)
  v_smfmac_f32_32x32x32_bf16 v[224:239], v[28:31], v[52:59], v10
  v_exp_f32 v62, v62
  v_exp_f32 v63, v63
  v_exp_f32 v64, v64
  v_exp_f32 v65, v65
  v_exp_f32 v66, v66
  v_exp_f32 v67, v67
  v_exp_f32 v36, v36
  v_exp_f32 v37, v37
  v_exp_f32 v38, v38
  s_waitcnt lgkmcnt(1)
  v_smfmac_f32_32x32x32_bf16 v[224:239], v[32:35], v[60:67], v10
  v_exp_f32 v39, v39
  v_exp_f32 v40, v40
  v_exp_f32 v41, v41
  s_waitcnt lgkmcnt(0)
  v_mfma_f32_32x32x16_bf16 v[52:67], v[24:27], v[16:19], 0
  v_exp_f32 v42, v42
  v_exp_f32 v43, v43
  v_exp_f32 v44, v44
  v_exp_f32 v45, v45
  v_smfmac_f32_32x32x32_bf16 v[240:255], v[28:31], v[36:43], v10
  s_mov_b64 exec, s[36:37]
  ds_read_b128 v[28:31], v8 offset:4096
  s_mov_b64 exec, -1
  v_exp_f32 v46, v46
  v_exp_f32 v47, v47
  v_exp_f32 v48, v48
  v_exp_f32 v49, v49
  v_exp_f32 v50, v50
  v_exp_f32 v51, v51
  v_add_u32 v7, 4096, v7
  v_add_u32 v8, 4096, v8
.p2align 3
recurrent_scan__grouped_kv_mqa__swiglu_ffn__prompt_kernel_l1:
  s_cbranch_vccz recurrent_scan__grouped_kv_mqa__swiglu_ffn__prompt_kernel_g4p0
  s_setprio 2
recurrent_scan__grouped_kv_mqa__swiglu_ffn__prompt_kernel_g4p0:
  s_waitcnt vmcnt(12)
  v_exp_f32 v52, v52
  v_exp_f32 v53, v53
  v_exp_f32 v54, v54
  v_smfmac_f32_32x32x32_bf16 v[240:255], v[32:35], v[44:51], v10
  s_mov_b64 exec, s[36:37]
  ds_read_b128 v[32:35], v8 offset:512
  s_mov_b64 exec, -1
  v_exp_f32 v55, v55
  buffer_load_dwordx4 v[172:175], v9, s[8:11], s48 offen sc1
  buffer_load_dwordx4 v[176:179], v9, s[8:11], s49 offen sc1
  buffer_load_dwordx4 v[180:183], v9, s[8:11], s44 offen sc1
  v_exp_f32 v56, v56
  v_exp_f32 v57, v57
  v_mfma_f32_32x32x16_bf16 v[36:51], v[24:27], v[20:23], 0
  ds_read_b128 v[24:27], v7 offset:1024
  v_exp_f32 v58, v58
  v_exp_f32 v59, v59
  v_exp_f32 v60, v60
  v_exp_f32 v61, v61
  s_waitcnt lgkmcnt(2)
  v_smfmac_f32_32x32x32_bf16 v[224:239], v[28:31], v[52:59], v10
  v_exp_f32 v62, v62
  v_exp_f32 v63, v63
  v_exp_f32 v64, v64
  v_mfma_f32_16x16x32_bf16 v[68:71], v[100:103], v[108:111], v[68:71]
  v_exp_f32 v65, v65
  v_mfma_f32_16x16x32_bf16 v[72:75], v[100:103], v[112:115], v[72:75]
  v_exp_f32 v66, v66
  v_mfma_f32_16x16x32_bf16 v[76:79], v[100:103], v[116:119], v[76:79]
  v_exp_f32 v67, v67
  v_mfma_f32_16x16x32_bf16 v[80:83], v[100:103], v[120:123], v[80:83]
  v_exp_f32 v36, v36
  v_exp_f32 v37, v37
  v_exp_f32 v38, v38
  s_waitcnt lgkmcnt(1)
  v_smfmac_f32_32x32x32_bf16 v[224:239], v[32:35], v[60:67], v10
  v_exp_f32 v39, v39
  buffer_load_dwordx4 v[184:187], v9, s[8:11], s45 offen sc1
  buffer_load_dwordx4 v[188:191], v9, s[8:11], s46 offen sc1
  buffer_load_dwordx4 v[192:195], v9, s[8:11], s47 offen sc1
  v_add_u32 v9, 1024, v9
  v_exp_f32 v40, v40
  v_exp_f32 v41, v41
  s_waitcnt lgkmcnt(0)
  v_mfma_f32_32x32x16_bf16 v[52:67], v[24:27], v[16:19], 0
  v_exp_f32 v42, v42
  v_exp_f32 v43, v43
  v_exp_f32 v44, v44
  v_exp_f32 v45, v45
  v_smfmac_f32_32x32x32_bf16 v[240:255], v[28:31], v[36:43], v10
  s_mov_b64 exec, s[36:37]
  ds_read_b128 v[28:31], v8 offset:1024
  s_mov_b64 exec, -1
  v_exp_f32 v46, v46
  v_exp_f32 v47, v47
  v_exp_f32 v48, v48
  v_mfma_f32_16x16x32_bf16 v[84:87], v[104:107], v[108:111], v[84:87]
  v_exp_f32 v49, v49
  v_mfma_f32_16x16x32_bf16 v[88:91], v[104:107], v[112:115], v[88:91]
  v_exp_f32 v50, v50
  v_mfma_f32_16x16x32_bf16 v[92:95], v[104:107], v[116:119], v[92:95]
  v_exp_f32 v51, v51
  v_mfma_f32_16x16x32_bf16 v[96:99], v[104:107], v[120:123], v[96:99]
  s_waitcnt vmcnt(12)
  v_exp_f32 v52, v52
  v_exp_f32 v53, v53
  v_exp_f32 v54, v54
  v_smfmac_f32_32x32x32_bf16 v[240:255], v[32:35], v[44:51], v10
  s_mov_b64 exec, s[36:37]
  ds_read_b128 v[32:35], v8 offset:1536
  s_mov_b64 exec, -1
  v_exp_f32 v55, v55
  buffer_load_dwordx4 v[100:103], v9, s[8:11], s48 offen sc1
  buffer_load_dwordx4 v[104:107], v9, s[8:11], s49 offen sc1
  buffer_load_dwordx4 v[108:111], v9, s[8:11], s44 offen sc1
  v_exp_f32 v56, v56
  v_exp_f32 v57, v57
  v_mfma_f32_32x32x16_bf16 v[36:51], v[24:27], v[20:23], 0
  ds_read_b128 v[24:27], v7 offset:2048
  v_exp_f32 v58, v58
  v_exp_f32 v59, v59
  v_exp_f32 v60, v60
  v_exp_f32 v61, v61
  s_waitcnt lgkmcnt(2)
  v_smfmac_f32_32x32x32_bf16 v[224:239], v[28:31], v[52:59], v10
  v_exp_f32 v62, v62
  v_exp_f32 v63, v63
  v_exp_f32 v64, v64
  v_mfma_f32_16x16x32_bf16 v[68:71], v[124:127], v[132:135], v[68:71]
  v_exp_f32 v65, v65
  v_mfma_f32_16x16x32_bf16 v[72:75], v[124:127], v[136:139], v[72:75]
  v_exp_f32 v66, v66
  v_mfma_f32_16x16x32_bf16 v[76:79], v[124:127], v[140:143], v[76:79]
  v_exp_f32 v67, v67
  v_mfma_f32_16x16x32_bf16 v[80:83], v[124:127], v[144:147], v[80:83]
  v_exp_f32 v36, v36
  v_exp_f32 v37, v37
  v_exp_f32 v38, v38
  s_waitcnt lgkmcnt(1)
  v_smfmac_f32_32x32x32_bf16 v[224:239], v[32:35], v[60:67], v10
  v_exp_f32 v39, v39
  buffer_load_dwordx4 v[112:115], v9, s[8:11], s45 offen sc1
  buffer_load_dwordx4 v[116:119], v9, s[8:11], s46 offen sc1
  buffer_load_dwordx4 v[120:123], v9, s[8:11], s47 offen sc1
  v_add_u32 v9, 1024, v9
  v_exp_f32 v40, v40
  v_exp_f32 v41, v41
  s_waitcnt lgkmcnt(0)
  v_mfma_f32_32x32x16_bf16 v[52:67], v[24:27], v[16:19], 0
  v_exp_f32 v42, v42
  v_exp_f32 v43, v43
  v_exp_f32 v44, v44
  v_exp_f32 v45, v45
  v_smfmac_f32_32x32x32_bf16 v[240:255], v[28:31], v[36:43], v10
  s_mov_b64 exec, s[36:37]
  ds_read_b128 v[28:31], v8 offset:2048
  s_mov_b64 exec, -1
  v_exp_f32 v46, v46
  v_exp_f32 v47, v47
  v_exp_f32 v48, v48
  v_mfma_f32_16x16x32_bf16 v[84:87], v[128:131], v[132:135], v[84:87]
  v_exp_f32 v49, v49
  v_mfma_f32_16x16x32_bf16 v[88:91], v[128:131], v[136:139], v[88:91]
  v_exp_f32 v50, v50
  v_mfma_f32_16x16x32_bf16 v[92:95], v[128:131], v[140:143], v[92:95]
  v_exp_f32 v51, v51
  v_mfma_f32_16x16x32_bf16 v[96:99], v[128:131], v[144:147], v[96:99]
  s_waitcnt vmcnt(12)
  v_exp_f32 v52, v52
  v_exp_f32 v53, v53
  v_exp_f32 v54, v54
  v_smfmac_f32_32x32x32_bf16 v[240:255], v[32:35], v[44:51], v10
  s_mov_b64 exec, s[36:37]
  ds_read_b128 v[32:35], v8 offset:2560
  s_mov_b64 exec, -1
  v_exp_f32 v55, v55
  buffer_load_dwordx4 v[124:127], v9, s[8:11], s48 offen sc1
  buffer_load_dwordx4 v[128:131], v9, s[8:11], s49 offen sc1
  buffer_load_dwordx4 v[132:135], v9, s[8:11], s44 offen sc1
  v_exp_f32 v56, v56
  v_exp_f32 v57, v57
  v_mfma_f32_32x32x16_bf16 v[36:51], v[24:27], v[20:23], 0
  ds_read_b128 v[24:27], v7 offset:3072
  v_exp_f32 v58, v58
  v_exp_f32 v59, v59
  v_exp_f32 v60, v60
  v_exp_f32 v61, v61
  s_waitcnt lgkmcnt(2)
  v_smfmac_f32_32x32x32_bf16 v[224:239], v[28:31], v[52:59], v10
  v_exp_f32 v62, v62
  v_exp_f32 v63, v63
  v_exp_f32 v64, v64
  v_mfma_f32_16x16x32_bf16 v[68:71], v[148:151], v[156:159], v[68:71]
  v_exp_f32 v65, v65
  v_mfma_f32_16x16x32_bf16 v[72:75], v[148:151], v[160:163], v[72:75]
  v_exp_f32 v66, v66
  v_mfma_f32_16x16x32_bf16 v[76:79], v[148:151], v[164:167], v[76:79]
  v_exp_f32 v67, v67
  v_mfma_f32_16x16x32_bf16 v[80:83], v[148:151], v[168:171], v[80:83]
  v_exp_f32 v36, v36
  v_exp_f32 v37, v37
  v_exp_f32 v38, v38
  s_waitcnt lgkmcnt(1)
  v_smfmac_f32_32x32x32_bf16 v[224:239], v[32:35], v[60:67], v10
  v_exp_f32 v39, v39
  buffer_load_dwordx4 v[136:139], v9, s[8:11], s45 offen sc1
  buffer_load_dwordx4 v[140:143], v9, s[8:11], s46 offen sc1
  buffer_load_dwordx4 v[144:147], v9, s[8:11], s47 offen sc1
  v_add_u32 v9, 1024, v9
  v_exp_f32 v40, v40
  v_exp_f32 v41, v41
  s_waitcnt lgkmcnt(0)
  v_mfma_f32_32x32x16_bf16 v[52:67], v[24:27], v[16:19], 0
  v_exp_f32 v42, v42
  v_exp_f32 v43, v43
  v_exp_f32 v44, v44
  v_exp_f32 v45, v45
  v_smfmac_f32_32x32x32_bf16 v[240:255], v[28:31], v[36:43], v10
  s_mov_b64 exec, s[36:37]
  ds_read_b128 v[28:31], v8 offset:3072
  s_mov_b64 exec, -1
  v_exp_f32 v46, v46
  v_exp_f32 v47, v47
  v_exp_f32 v48, v48
  v_mfma_f32_16x16x32_bf16 v[84:87], v[152:155], v[156:159], v[84:87]
  v_exp_f32 v49, v49
  v_mfma_f32_16x16x32_bf16 v[88:91], v[152:155], v[160:163], v[88:91]
  v_exp_f32 v50, v50
  v_mfma_f32_16x16x32_bf16 v[92:95], v[152:155], v[164:167], v[92:95]
  v_exp_f32 v51, v51
  v_mfma_f32_16x16x32_bf16 v[96:99], v[152:155], v[168:171], v[96:99]
  s_waitcnt vmcnt(12)
  s_cbranch_vccz recurrent_scan__grouped_kv_mqa__swiglu_ffn__prompt_kernel_g4p1
  s_setprio 0
recurrent_scan__grouped_kv_mqa__swiglu_ffn__prompt_kernel_g4p1:
  v_exp_f32 v52, v52
  v_exp_f32 v53, v53
  v_exp_f32 v54, v54
  v_smfmac_f32_32x32x32_bf16 v[240:255], v[32:35], v[44:51], v10
  s_mov_b64 exec, s[36:37]
  ds_read_b128 v[32:35], v8 offset:3584
  s_mov_b64 exec, -1
  v_exp_f32 v55, v55
  buffer_load_dwordx4 v[148:151], v9, s[8:11], s48 offen sc1
  buffer_load_dwordx4 v[152:155], v9, s[8:11], s49 offen sc1
  buffer_load_dwordx4 v[156:159], v9, s[8:11], s44 offen sc1
  v_exp_f32 v56, v56
  v_exp_f32 v57, v57
  v_mfma_f32_32x32x16_bf16 v[36:51], v[24:27], v[20:23], 0
  ds_read_b128 v[24:27], v7 offset:4096
  v_exp_f32 v58, v58
  v_exp_f32 v59, v59
  v_exp_f32 v60, v60
  v_exp_f32 v61, v61
  s_waitcnt lgkmcnt(2)
  v_smfmac_f32_32x32x32_bf16 v[224:239], v[28:31], v[52:59], v10
  v_exp_f32 v62, v62
  v_exp_f32 v63, v63
  v_exp_f32 v64, v64
  v_mfma_f32_16x16x32_bf16 v[68:71], v[172:175], v[180:183], v[68:71]
  v_exp_f32 v65, v65
  v_mfma_f32_16x16x32_bf16 v[72:75], v[172:175], v[184:187], v[72:75]
  v_exp_f32 v66, v66
  v_mfma_f32_16x16x32_bf16 v[76:79], v[172:175], v[188:191], v[76:79]
  v_exp_f32 v67, v67
  v_mfma_f32_16x16x32_bf16 v[80:83], v[172:175], v[192:195], v[80:83]
  v_exp_f32 v36, v36
  v_exp_f32 v37, v37
  v_exp_f32 v38, v38
  s_waitcnt lgkmcnt(1)
  v_smfmac_f32_32x32x32_bf16 v[224:239], v[32:35], v[60:67], v10
  v_exp_f32 v39, v39
  buffer_load_dwordx4 v[160:163], v9, s[8:11], s45 offen sc1
  buffer_load_dwordx4 v[164:167], v9, s[8:11], s46 offen sc1
  buffer_load_dwordx4 v[168:171], v9, s[8:11], s47 offen sc1
  v_add_u32 v9, 1024, v9
  v_exp_f32 v40, v40
  v_exp_f32 v41, v41
  s_waitcnt lgkmcnt(0)
  v_mfma_f32_32x32x16_bf16 v[52:67], v[24:27], v[16:19], 0
  v_exp_f32 v42, v42
  v_exp_f32 v43, v43
  v_exp_f32 v44, v44
  v_exp_f32 v45, v45
  v_smfmac_f32_32x32x32_bf16 v[240:255], v[28:31], v[36:43], v10
  s_mov_b64 exec, s[36:37]
  ds_read_b128 v[28:31], v8 offset:4096
  s_mov_b64 exec, -1
  v_exp_f32 v46, v46
  v_exp_f32 v47, v47
  v_exp_f32 v48, v48
  v_mfma_f32_16x16x32_bf16 v[84:87], v[176:179], v[180:183], v[84:87]
  v_exp_f32 v49, v49
  v_mfma_f32_16x16x32_bf16 v[88:91], v[176:179], v[184:187], v[88:91]
  v_exp_f32 v50, v50
  v_mfma_f32_16x16x32_bf16 v[92:95], v[176:179], v[188:191], v[92:95]
  v_exp_f32 v51, v51
  v_mfma_f32_16x16x32_bf16 v[96:99], v[176:179], v[192:195], v[96:99]
  v_add_u32 v7, 4096, v7
  v_add_u32 v8, 4096, v8
  s_add_u32 s72, s72, 1
  s_cmp_lt_u32 s72, 2
  s_cbranch_scc1 recurrent_scan__grouped_kv_mqa__swiglu_ffn__prompt_kernel_l1
  s_cbranch_vccz recurrent_scan__grouped_kv_mqa__swiglu_ffn__prompt_kernel_g4bp0
  s_setprio 2
recurrent_scan__grouped_kv_mqa__swiglu_ffn__prompt_kernel_g4bp0:
  s_waitcnt vmcnt(12)
  v_exp_f32 v52, v52
  v_exp_f32 v53, v53
  v_exp_f32 v54, v54
  v_smfmac_f32_32x32x32_bf16 v[240:255], v[32:35], v[44:51], v10
  s_mov_b64 exec, s[36:37]
  ds_read_b128 v[32:35], v8 offset:512
  s_mov_b64 exec, -1
  v_exp_f32 v55, v55
  buffer_load_dwordx4 v[172:175], v9, s[8:11], s48 offen sc1
  buffer_load_dwordx4 v[176:179], v9, s[8:11], s49 offen sc1
  buffer_load_dwordx4 v[180:183], v9, s[8:11], s44 offen sc1
  v_exp_f32 v56, v56
  v_exp_f32 v57, v57
  v_mfma_f32_32x32x16_bf16 v[36:51], v[24:27], v[20:23], 0
  ds_read_b128 v[24:27], v7 offset:1024
  v_exp_f32 v58, v58
  v_exp_f32 v59, v59
  v_exp_f32 v60, v60
  v_exp_f32 v61, v61
  s_waitcnt lgkmcnt(2)
  v_smfmac_f32_32x32x32_bf16 v[224:239], v[28:31], v[52:59], v10
  v_exp_f32 v62, v62
  v_exp_f32 v63, v63
  v_exp_f32 v64, v64
  v_mfma_f32_16x16x32_bf16 v[68:71], v[100:103], v[108:111], v[68:71]
  v_exp_f32 v65, v65
  v_mfma_f32_16x16x32_bf16 v[72:75], v[100:103], v[112:115], v[72:75]
  v_exp_f32 v66, v66
  v_mfma_f32_16x16x32_bf16 v[76:79], v[100:103], v[116:119], v[76:79]
  v_exp_f32 v67, v67
  v_mfma_f32_16x16x32_bf16 v[80:83], v[100:103], v[120:123], v[80:83]
  v_exp_f32 v36, v36
  v_exp_f32 v37, v37
  v_exp_f32 v38, v38
  s_waitcnt lgkmcnt(1)
  v_smfmac_f32_32x32x32_bf16 v[224:239], v[32:35], v[60:67], v10
  v_exp_f32 v39, v39
  buffer_load_dwordx4 v[184:187], v9, s[8:11], s45 offen sc1
  buffer_load_dwordx4 v[188:191], v9, s[8:11], s46 offen sc1
  buffer_load_dwordx4 v[192:195], v9, s[8:11], s47 offen sc1
  v_add_u32 v9, 1024, v9
  v_exp_f32 v40, v40
  v_exp_f32 v41, v41
  s_waitcnt lgkmcnt(0)
  v_mfma_f32_32x32x16_bf16 v[52:67], v[24:27], v[16:19], 0
  v_exp_f32 v42, v42
  v_exp_f32 v43, v43
  v_exp_f32 v44, v44
  v_exp_f32 v45, v45
  v_smfmac_f32_32x32x32_bf16 v[240:255], v[28:31], v[36:43], v10
  s_mov_b64 exec, s[36:37]
  ds_read_b128 v[28:31], v8 offset:1024
  s_mov_b64 exec, -1
  v_exp_f32 v46, v46
  v_exp_f32 v47, v47
  v_exp_f32 v48, v48
  v_mfma_f32_16x16x32_bf16 v[84:87], v[104:107], v[108:111], v[84:87]
  v_exp_f32 v49, v49
  v_mfma_f32_16x16x32_bf16 v[88:91], v[104:107], v[112:115], v[88:91]
  v_exp_f32 v50, v50
  v_mfma_f32_16x16x32_bf16 v[92:95], v[104:107], v[116:119], v[92:95]
  v_exp_f32 v51, v51
  v_mfma_f32_16x16x32_bf16 v[96:99], v[104:107], v[120:123], v[96:99]
  s_waitcnt vmcnt(12)
  v_exp_f32 v52, v52
  v_exp_f32 v53, v53
  v_exp_f32 v54, v54
  v_smfmac_f32_32x32x32_bf16 v[240:255], v[32:35], v[44:51], v10
  s_mov_b64 exec, s[36:37]
  ds_read_b128 v[32:35], v8 offset:1536
  s_mov_b64 exec, -1
  v_exp_f32 v55, v55
  buffer_load_dwordx4 v[100:103], v9, s[8:11], s48 offen sc1
  buffer_load_dwordx4 v[104:107], v9, s[8:11], s49 offen sc1
  buffer_load_dwordx4 v[108:111], v9, s[8:11], s44 offen sc1
  v_exp_f32 v56, v56
  v_exp_f32 v57, v57
  v_mfma_f32_32x32x16_bf16 v[36:51], v[24:27], v[20:23], 0
  ds_read_b128 v[24:27], v7 offset:2048
  v_exp_f32 v58, v58
  v_exp_f32 v59, v59
  v_exp_f32 v60, v60
  v_exp_f32 v61, v61
  s_waitcnt lgkmcnt(2)
  v_smfmac_f32_32x32x32_bf16 v[224:239], v[28:31], v[52:59], v10
  v_exp_f32 v62, v62
  v_exp_f32 v63, v63
  v_exp_f32 v64, v64
  v_mfma_f32_16x16x32_bf16 v[68:71], v[124:127], v[132:135], v[68:71]
  v_exp_f32 v65, v65
  v_mfma_f32_16x16x32_bf16 v[72:75], v[124:127], v[136:139], v[72:75]
  v_exp_f32 v66, v66
  v_mfma_f32_16x16x32_bf16 v[76:79], v[124:127], v[140:143], v[76:79]
  v_exp_f32 v67, v67
  v_mfma_f32_16x16x32_bf16 v[80:83], v[124:127], v[144:147], v[80:83]
  v_exp_f32 v36, v36
  v_exp_f32 v37, v37
  v_exp_f32 v38, v38
  s_waitcnt lgkmcnt(1)
  v_smfmac_f32_32x32x32_bf16 v[224:239], v[32:35], v[60:67], v10
  v_exp_f32 v39, v39
  buffer_load_dwordx4 v[112:115], v9, s[8:11], s45 offen sc1
  buffer_load_dwordx4 v[116:119], v9, s[8:11], s46 offen sc1
  buffer_load_dwordx4 v[120:123], v9, s[8:11], s47 offen sc1
  v_add_u32 v9, 1024, v9
  v_exp_f32 v40, v40
  v_exp_f32 v41, v41
  s_waitcnt lgkmcnt(0)
  v_mfma_f32_32x32x16_bf16 v[52:67], v[24:27], v[16:19], 0
  v_exp_f32 v42, v42
  v_exp_f32 v43, v43
  v_exp_f32 v44, v44
  v_exp_f32 v45, v45
  v_smfmac_f32_32x32x32_bf16 v[240:255], v[28:31], v[36:43], v10
  s_mov_b64 exec, s[36:37]
  ds_read_b128 v[28:31], v8 offset:2048
  s_mov_b64 exec, -1
  v_exp_f32 v46, v46
  v_exp_f32 v47, v47
  v_exp_f32 v48, v48
  v_mfma_f32_16x16x32_bf16 v[84:87], v[128:131], v[132:135], v[84:87]
  v_exp_f32 v49, v49
  v_mfma_f32_16x16x32_bf16 v[88:91], v[128:131], v[136:139], v[88:91]
  v_exp_f32 v50, v50
  v_mfma_f32_16x16x32_bf16 v[92:95], v[128:131], v[140:143], v[92:95]
  v_exp_f32 v51, v51
  v_mfma_f32_16x16x32_bf16 v[96:99], v[128:131], v[144:147], v[96:99]
  s_waitcnt vmcnt(12)
  v_exp_f32 v52, v52
  v_exp_f32 v53, v53
  v_exp_f32 v54, v54
  v_smfmac_f32_32x32x32_bf16 v[240:255], v[32:35], v[44:51], v10
  s_mov_b64 exec, s[36:37]
  ds_read_b128 v[32:35], v8 offset:2560
  s_mov_b64 exec, -1
  v_exp_f32 v55, v55
  buffer_load_dwordx4 v[124:127], v9, s[8:11], s48 offen sc1
  buffer_load_dwordx4 v[128:131], v9, s[8:11], s49 offen sc1
  buffer_load_dwordx4 v[132:135], v9, s[8:11], s44 offen sc1
  v_exp_f32 v56, v56
  v_exp_f32 v57, v57
  v_mfma_f32_32x32x16_bf16 v[36:51], v[24:27], v[20:23], 0
  ds_read_b128 v[24:27], v7 offset:3072
  v_exp_f32 v58, v58
  v_exp_f32 v59, v59
  v_exp_f32 v60, v60
  v_exp_f32 v61, v61
  s_waitcnt lgkmcnt(2)
  v_smfmac_f32_32x32x32_bf16 v[224:239], v[28:31], v[52:59], v10
  v_exp_f32 v62, v62
  v_exp_f32 v63, v63
  v_exp_f32 v64, v64
  v_mfma_f32_16x16x32_bf16 v[68:71], v[148:151], v[156:159], v[68:71]
  v_exp_f32 v65, v65
  v_mfma_f32_16x16x32_bf16 v[72:75], v[148:151], v[160:163], v[72:75]
  v_exp_f32 v66, v66
  v_mfma_f32_16x16x32_bf16 v[76:79], v[148:151], v[164:167], v[76:79]
  v_exp_f32 v67, v67
  v_mfma_f32_16x16x32_bf16 v[80:83], v[148:151], v[168:171], v[80:83]
  v_exp_f32 v36, v36
  v_exp_f32 v37, v37
  v_exp_f32 v38, v38
  s_waitcnt lgkmcnt(1)
  v_smfmac_f32_32x32x32_bf16 v[224:239], v[32:35], v[60:67], v10
  v_exp_f32 v39, v39
  buffer_load_dwordx4 v[136:139], v9, s[8:11], s45 offen sc1
  buffer_load_dwordx4 v[140:143], v9, s[8:11], s46 offen sc1
  buffer_load_dwordx4 v[144:147], v9, s[8:11], s47 offen sc1
  v_add_u32 v9, 1024, v9
  v_exp_f32 v40, v40
  v_exp_f32 v41, v41
  s_waitcnt lgkmcnt(0)
  v_mfma_f32_32x32x16_bf16 v[52:67], v[24:27], v[16:19], 0
  v_exp_f32 v42, v42
  v_exp_f32 v43, v43
  v_exp_f32 v44, v44
  v_exp_f32 v45, v45
  v_smfmac_f32_32x32x32_bf16 v[240:255], v[28:31], v[36:43], v10
  s_mov_b64 exec, s[36:37]
  ds_read_b128 v[28:31], v8 offset:3072
  s_mov_b64 exec, -1
  v_exp_f32 v46, v46
  v_exp_f32 v47, v47
  v_exp_f32 v48, v48
  v_mfma_f32_16x16x32_bf16 v[84:87], v[152:155], v[156:159], v[84:87]
  v_exp_f32 v49, v49
  v_mfma_f32_16x16x32_bf16 v[88:91], v[152:155], v[160:163], v[88:91]
  v_exp_f32 v50, v50
  v_mfma_f32_16x16x32_bf16 v[92:95], v[152:155], v[164:167], v[92:95]
  v_exp_f32 v51, v51
  v_mfma_f32_16x16x32_bf16 v[96:99], v[152:155], v[168:171], v[96:99]
  s_waitcnt vmcnt(12)
  s_cbranch_vccz recurrent_scan__grouped_kv_mqa__swiglu_ffn__prompt_kernel_g4bp1
  s_setprio 0
recurrent_scan__grouped_kv_mqa__swiglu_ffn__prompt_kernel_g4bp1:
  v_exp_f32 v52, v52
  v_exp_f32 v53, v53
  v_exp_f32 v54, v54
  v_smfmac_f32_32x32x32_bf16 v[240:255], v[32:35], v[44:51], v10
  s_mov_b64 exec, s[36:37]
  ds_read_b128 v[32:35], v8 offset:3584
  s_mov_b64 exec, -1
  v_exp_f32 v55, v55
  v_exp_f32 v56, v56
  v_exp_f32 v57, v57
  v_mfma_f32_32x32x16_bf16 v[36:51], v[24:27], v[20:23], 0
  ds_read_b128 v[24:27], v7 offset:4096
  v_exp_f32 v58, v58
  v_exp_f32 v59, v59
  v_exp_f32 v60, v60
  v_exp_f32 v61, v61
  s_waitcnt lgkmcnt(2)
  v_smfmac_f32_32x32x32_bf16 v[224:239], v[28:31], v[52:59], v10
  v_exp_f32 v62, v62
  v_exp_f32 v63, v63
  v_exp_f32 v64, v64
  v_mfma_f32_16x16x32_bf16 v[68:71], v[172:175], v[180:183], v[68:71]
  v_exp_f32 v65, v65
  v_mfma_f32_16x16x32_bf16 v[72:75], v[172:175], v[184:187], v[72:75]
  v_exp_f32 v66, v66
  v_mfma_f32_16x16x32_bf16 v[76:79], v[172:175], v[188:191], v[76:79]
  v_exp_f32 v67, v67
  v_mfma_f32_16x16x32_bf16 v[80:83], v[172:175], v[192:195], v[80:83]
  v_exp_f32 v36, v36
  v_exp_f32 v37, v37
  v_exp_f32 v38, v38
  s_waitcnt lgkmcnt(1)
  v_smfmac_f32_32x32x32_bf16 v[224:239], v[32:35], v[60:67], v10
  v_exp_f32 v39, v39
  v_exp_f32 v40, v40
  v_exp_f32 v41, v41
  s_waitcnt lgkmcnt(0)
  v_mfma_f32_32x32x16_bf16 v[52:67], v[24:27], v[16:19], 0
  v_exp_f32 v42, v42
  v_exp_f32 v43, v43
  v_exp_f32 v44, v44
  v_exp_f32 v45, v45
  v_smfmac_f32_32x32x32_bf16 v[240:255], v[28:31], v[36:43], v10
  s_mov_b64 exec, s[36:37]
  ds_read_b128 v[28:31], v8 offset:4096
  s_mov_b64 exec, -1
  v_exp_f32 v46, v46
  v_exp_f32 v47, v47
  v_exp_f32 v48, v48
  v_mfma_f32_16x16x32_bf16 v[84:87], v[176:179], v[180:183], v[84:87]
  v_exp_f32 v49, v49
  v_mfma_f32_16x16x32_bf16 v[88:91], v[176:179], v[184:187], v[88:91]
  v_exp_f32 v50, v50
  v_mfma_f32_16x16x32_bf16 v[92:95], v[176:179], v[188:191], v[92:95]
  v_exp_f32 v51, v51
  v_mfma_f32_16x16x32_bf16 v[96:99], v[176:179], v[192:195], v[96:99]
  v_add_u32 v7, 4096, v7
  v_add_u32 v8, 4096, v8
  s_cbranch_vccz recurrent_scan__grouped_kv_mqa__swiglu_ffn__prompt_kernel_g2p0
  s_setprio 2
recurrent_scan__grouped_kv_mqa__swiglu_ffn__prompt_kernel_g2p0:
  s_waitcnt vmcnt(6)
  v_exp_f32 v52, v52
  v_exp_f32 v53, v53
  v_exp_f32 v54, v54
  v_smfmac_f32_32x32x32_bf16 v[240:255], v[32:35], v[44:51], v10
  s_mov_b64 exec, s[36:37]
  ds_read_b128 v[32:35], v8 offset:512
  s_mov_b64 exec, -1
  v_exp_f32 v55, v55
  v_exp_f32 v56, v56
  v_exp_f32 v57, v57
  v_mfma_f32_32x32x16_bf16 v[36:51], v[24:27], v[20:23], 0
  ds_read_b128 v[24:27], v7 offset:1024
  v_exp_f32 v58, v58
  v_exp_f32 v59, v59
  v_exp_f32 v60, v60
  v_exp_f32 v61, v61
  s_waitcnt lgkmcnt(2)
  v_smfmac_f32_32x32x32_bf16 v[224:239], v[28:31], v[52:59], v10
  v_exp_f32 v62, v62
  v_exp_f32 v63, v63
  v_exp_f32 v64, v64
  v_mfma_f32_16x16x32_bf16 v[68:71], v[100:103], v[108:111], v[68:71]
  v_exp_f32 v65, v65
  v_exp_f32 v66, v66
  v_mfma_f32_16x16x32_bf16 v[72:75], v[100:103], v[112:115], v[72:75]
  v_exp_f32 v67, v67
  v_exp_f32 v36, v36
  v_exp_f32 v37, v37
  v_exp_f32 v38, v38
  s_waitcnt lgkmcnt(1)
  v_smfmac_f32_32x32x32_bf16 v[224:239], v[32:35], v[60:67], v10
  v_exp_f32 v39, v39
  v_exp_f32 v40, v40
  v_exp_f32 v41, v41
  s_waitcnt lgkmcnt(0)
  v_mfma_f32_32x32x16_bf16 v[52:67], v[24:27], v[16:19], 0
  v_exp_f32 v42, v42
  v_exp_f32 v43, v43
  v_exp_f32 v44, v44
  v_exp_f32 v45, v45
  v_smfmac_f32_32x32x32_bf16 v[240:255], v[28:31], v[36:43], v10
  s_mov_b64 exec, s[36:37]
  ds_read_b128 v[28:31], v8 offset:1024
  s_mov_b64 exec, -1
  v_exp_f32 v46, v46
  v_exp_f32 v47, v47
  v_exp_f32 v48, v48
  v_mfma_f32_16x16x32_bf16 v[76:79], v[100:103], v[116:119], v[76:79]
  v_exp_f32 v49, v49
  v_exp_f32 v50, v50
  v_mfma_f32_16x16x32_bf16 v[80:83], v[100:103], v[120:123], v[80:83]
  v_exp_f32 v51, v51
  v_exp_f32 v52, v52
  v_exp_f32 v53, v53
  v_exp_f32 v54, v54
  v_smfmac_f32_32x32x32_bf16 v[240:255], v[32:35], v[44:51], v10
  s_mov_b64 exec, s[36:37]
  ds_read_b128 v[32:35], v8 offset:1536
  s_mov_b64 exec, -1
  v_exp_f32 v55, v55
  v_exp_f32 v56, v56
  v_exp_f32 v57, v57
  v_mfma_f32_32x32x16_bf16 v[36:51], v[24:27], v[20:23], 0
  ds_read_b128 v[24:27], v7 offset:2048
  v_exp_f32 v58, v58
  v_exp_f32 v59, v59
  v_exp_f32 v60, v60
  v_exp_f32 v61, v61
  s_waitcnt lgkmcnt(2)
  v_smfmac_f32_32x32x32_bf16 v[224:239], v[28:31], v[52:59], v10
  v_exp_f32 v62, v62
  v_exp_f32 v63, v63
  v_exp_f32 v64, v64
  v_mfma_f32_16x16x32_bf16 v[84:87], v[104:107], v[108:111], v[84:87]
  v_exp_f32 v65, v65
  v_exp_f32 v66, v66
  v_mfma_f32_16x16x32_bf16 v[88:91], v[104:107], v[112:115], v[88:91]
  v_exp_f32 v67, v67
  v_exp_f32 v36, v36
  v_exp_f32 v37, v37
  v_exp_f32 v38, v38
  s_waitcnt lgkmcnt(1)
  v_smfmac_f32_32x32x32_bf16 v[224:239], v[32:35], v[60:67], v10
  v_exp_f32 v39, v39
  v_exp_f32 v40, v40
  v_exp_f32 v41, v41
  s_waitcnt lgkmcnt(0)
  v_mfma_f32_32x32x16_bf16 v[52:67], v[24:27], v[16:19], 0
  v_exp_f32 v42, v42
  v_exp_f32 v43, v43
  v_exp_f32 v44, v44
  v_exp_f32 v45, v45
  v_smfmac_f32_32x32x32_bf16 v[240:255], v[28:31], v[36:43], v10
  s_mov_b64 exec, s[36:37]
  ds_read_b128 v[28:31], v8 offset:2048
  s_mov_b64 exec, -1
  v_exp_f32 v46, v46
  v_exp_f32 v47, v47
  v_exp_f32 v48, v48
  v_mfma_f32_16x16x32_bf16 v[92:95], v[104:107], v[116:119], v[92:95]
  v_exp_f32 v49, v49
  v_exp_f32 v50, v50
  v_mfma_f32_16x16x32_bf16 v[96:99], v[104:107], v[120:123], v[96:99]
  v_exp_f32 v51, v51
  s_waitcnt vmcnt(0)
  v_exp_f32 v52, v52
  v_exp_f32 v53, v53
  v_exp_f32 v54, v54
  v_smfmac_f32_32x32x32_bf16 v[240:255], v[32:35], v[44:51], v10
  s_mov_b64 exec, s[36:37]
  ds_read_b128 v[32:35], v8 offset:2560
  s_mov_b64 exec, -1
  v_exp_f32 v55, v55
  v_exp_f32 v56, v56
  v_exp_f32 v57, v57
  v_mfma_f32_32x32x16_bf16 v[36:51], v[24:27], v[20:23], 0
  ds_read_b128 v[24:27], v7 offset:3072
  v_exp_f32 v58, v58
  v_exp_f32 v59, v59
  v_exp_f32 v60, v60
  v_exp_f32 v61, v61
  s_waitcnt lgkmcnt(2)
  v_smfmac_f32_32x32x32_bf16 v[224:239], v[28:31], v[52:59], v10
  v_exp_f32 v62, v62
  v_exp_f32 v63, v63
  v_exp_f32 v64, v64
  v_mfma_f32_16x16x32_bf16 v[68:71], v[124:127], v[132:135], v[68:71]
  v_exp_f32 v65, v65
  v_exp_f32 v66, v66
  v_mfma_f32_16x16x32_bf16 v[72:75], v[124:127], v[136:139], v[72:75]
  v_exp_f32 v67, v67
  v_exp_f32 v36, v36
  v_exp_f32 v37, v37
  v_exp_f32 v38, v38
  s_waitcnt lgkmcnt(1)
  v_smfmac_f32_32x32x32_bf16 v[224:239], v[32:35], v[60:67], v10
  v_exp_f32 v39, v39
  v_exp_f32 v40, v40
  v_exp_f32 v41, v41
  s_waitcnt lgkmcnt(0)
  v_mfma_f32_32x32x16_bf16 v[52:67], v[24:27], v[16:19], 0
  v_exp_f32 v42, v42
  v_exp_f32 v43, v43
  v_exp_f32 v44, v44
  v_exp_f32 v45, v45
  v_smfmac_f32_32x32x32_bf16 v[240:255], v[28:31], v[36:43], v10
  s_mov_b64 exec, s[36:37]
  ds_read_b128 v[28:31], v8 offset:3072
  s_mov_b64 exec, -1
  v_exp_f32 v46, v46
  v_exp_f32 v47, v47
  v_exp_f32 v48, v48
  v_mfma_f32_16x16x32_bf16 v[76:79], v[124:127], v[140:143], v[76:79]
  v_exp_f32 v49, v49
  v_exp_f32 v50, v50
  v_mfma_f32_16x16x32_bf16 v[80:83], v[124:127], v[144:147], v[80:83]
  v_exp_f32 v51, v51
  s_cbranch_vccz recurrent_scan__grouped_kv_mqa__swiglu_ffn__prompt_kernel_g2p1
  s_setprio 0
recurrent_scan__grouped_kv_mqa__swiglu_ffn__prompt_kernel_g2p1:
  v_exp_f32 v52, v52
  v_exp_f32 v53, v53
  v_exp_f32 v54, v54
  v_smfmac_f32_32x32x32_bf16 v[240:255], v[32:35], v[44:51], v10
  s_mov_b64 exec, s[36:37]
  ds_read_b128 v[32:35], v8 offset:3584
  s_mov_b64 exec, -1
  v_exp_f32 v55, v55
  v_exp_f32 v56, v56
  v_exp_f32 v57, v57
  v_mfma_f32_32x32x16_bf16 v[36:51], v[24:27], v[20:23], 0
  ds_read_b128 v[24:27], v7 offset:4096
  v_exp_f32 v58, v58
  v_exp_f32 v59, v59
  v_exp_f32 v60, v60
  v_exp_f32 v61, v61
  s_waitcnt lgkmcnt(2)
  v_smfmac_f32_32x32x32_bf16 v[224:239], v[28:31], v[52:59], v10
  v_exp_f32 v62, v62
  v_exp_f32 v63, v63
  v_exp_f32 v64, v64
  v_mfma_f32_16x16x32_bf16 v[84:87], v[128:131], v[132:135], v[84:87]
  v_exp_f32 v65, v65
  v_exp_f32 v66, v66
  v_mfma_f32_16x16x32_bf16 v[88:91], v[128:131], v[136:139], v[88:91]
  v_exp_f32 v67, v67
  v_exp_f32 v36, v36
  v_exp_f32 v37, v37
  v_exp_f32 v38, v38
  s_waitcnt lgkmcnt(1)
  v_smfmac_f32_32x32x32_bf16 v[224:239], v[32:35], v[60:67], v10
  v_exp_f32 v39, v39
  v_exp_f32 v40, v40
  v_exp_f32 v41, v41
  s_waitcnt lgkmcnt(0)
  v_mfma_f32_32x32x16_bf16 v[52:67], v[24:27], v[16:19], 0
  v_exp_f32 v42, v42
  v_exp_f32 v43, v43
  v_exp_f32 v44, v44
  v_exp_f32 v45, v45
  v_smfmac_f32_32x32x32_bf16 v[240:255], v[28:31], v[36:43], v10
  s_mov_b64 exec, s[36:37]
  ds_read_b128 v[28:31], v8 offset:4096
  s_mov_b64 exec, -1
  v_exp_f32 v46, v46
  v_exp_f32 v47, v47
  v_exp_f32 v48, v48
  v_mfma_f32_16x16x32_bf16 v[92:95], v[128:131], v[140:143], v[92:95]
  v_exp_f32 v49, v49
  v_exp_f32 v50, v50
  v_mfma_f32_16x16x32_bf16 v[96:99], v[128:131], v[144:147], v[96:99]
  v_exp_f32 v51, v51
  v_add_u32 v7, 4096, v7
  v_add_u32 v8, 4096, v8
  s_setprio 0
  s_nop 1
  v_smfmac_f32_32x32x32_bf16 v[240:255], v[32:35], v[44:51], v10
  s_mul_i32 s33, s4, 3072
  s_add_u32 s33, s33, 131072
  v_add_u32 v5, s33, v2
  s_xor_b32 s34, s4, 4
  s_mul_i32 s34, s34, 3072
  s_add_u32 s34, s34, 131072
  v_add_u32 v6, s34, v2
  v_mov_b32 v14, 0x67000000
  v_mov_b32 v15, 155648
  v_mov_b32 v55, 0x207
  s_nop 7
  s_nop 1
  ds_write_b128 v5, v[240:243]
  ds_write_b128 v5, v[244:247] offset:1024
  ds_write_b128 v5, v[248:251] offset:2048
  v_pk_add_f32 v[56:57], v[224:225], v[240:241]
  v_pk_add_f32 v[58:59], v[226:227], v[242:243]
  v_pk_add_f32 v[60:61], v[228:229], v[244:245]
  v_pk_add_f32 v[62:63], v[230:231], v[246:247]
  v_min_f32 v52, v232, v248
  v_pk_add_f32 v[56:57], v[56:57], v[58:59]
  v_max_f32 v53, v232, v248
  v_pk_add_f32 v[60:61], v[60:61], v[62:63]
  v_add_f32 v54, v232, v248
  v_pk_add_f32 v[56:57], v[56:57], v[60:61]
  v_add_f32 v54, v54, v56
  v_add_f32 v54, v54, v57
  v_cmp_nle_f32 vcc, 0x17800000, v52
  v_cmp_nge_f32 s[38:39], v14, v53
  v_cmp_class_f32 s[60:61], v54, v55
  s_nop 3
  s_or_b64 vcc, vcc, s[38:39]
  s_or_b64 vcc, vcc, s[60:61]
  s_cbranch_vccz recurrent_scan__grouped_kv_mqa__swiglu_ffn__prompt_kernel_safe
  v_mov_b32 v52, 1
  ds_write_b32 v15, v52
recurrent_scan__grouped_kv_mqa__swiglu_ffn__prompt_kernel_safe:
  s_waitcnt lgkmcnt(0)
  s_barrier
  ds_read_b32 v14, v15
  ds_read_b128 v[52:55], v6
  ds_read_b128 v[56:59], v6 offset:1024
  ds_read_b128 v[60:63], v6 offset:2048
  s_waitcnt lgkmcnt(3)
  v_readfirstlane_b32 s71, v14
  s_nop 3
  s_cmp_eq_u32 s71, 0
  s_cbranch_scc0 recurrent_scan__grouped_kv_mqa__swiglu_ffn__prompt_kernel_slow
  s_waitcnt lgkmcnt(0)
  v_pk_add_f32 v[224:225], v[224:225], v[52:53]
  v_pk_add_f32 v[226:227], v[226:227], v[54:55]
  v_pk_add_f32 v[228:229], v[228:229], v[56:57]
  v_pk_add_f32 v[230:231], v[230:231], v[58:59]
  v_add_f32 v232, v232, v60
recurrent_scan__grouped_kv_mqa__swiglu_ffn__prompt_kernel_ost:
  v_rcp_f32 v14, v232
  v_bfe_u32 v5, v1, 4, 1
  v_lshlrev_b32 v5, 14, v5
  v_lshrrev_b32 v6, 5, v1
  v_lshl_add_u32 v5, v6, 8, v5
  v_and_b32 v6, 15, v1
  v_lshl_add_u32 v5, v6, 4, v5
  s_lshl_b32 s33, s5, 3
  s_lshl_b32 s34, s69, 1
  s_add_u32 s33, s33, s34
  s_lshl_b32 s33, s33, 4
  s_add_u32 s33, s33, s6
  s_lshl_b32 s33, s33, 10
  s_lshl_b32 s34, s70, 9
  s_add_u32 s33, s33, s34
  s_add_u32 s33, s33, 15728640
  v_pk_mul_f32 v[224:225], v[224:225], v[14:15] op_sel_hi:[1,0]
  v_pk_mul_f32 v[226:227], v[226:227], v[14:15] op_sel_hi:[1,0]
  v_pk_mul_f32 v[228:229], v[228:229], v[14:15] op_sel_hi:[1,0]
  v_pk_mul_f32 v[230:231], v[230:231], v[14:15] op_sel_hi:[1,0]
  v_cvt_pk_bf16_f32 v36, v224, v225
  v_cvt_pk_bf16_f32 v37, v226, v227
  v_cvt_pk_bf16_f32 v38, v228, v229
  v_cvt_pk_bf16_f32 v39, v230, v231
  buffer_store_dwordx4 v[36:39], v5, s[8:11], s33 offen sc1
  s_lshl_b32 s33, s4, 10
  s_add_u32 m0, s33, 65536
  s_add_u32 s34, s75, 0
  buffer_load_dwordx4 v2, s[8:11], s34 offen  lds
  s_lshl_b32 s33, s4, 10
  s_add_u32 m0, s33, 73728
  s_add_u32 s34, s75, 8192
  buffer_load_dwordx4 v2, s[8:11], s34 offen  lds
  s_lshl_b32 s33, s4, 10
  s_add_u32 m0, s33, 81920
  s_add_u32 s34, s75, 16384
  buffer_load_dwordx4 v2, s[8:11], s34 offen  lds
  s_lshl_b32 s33, s4, 10
  s_add_u32 m0, s33, 90112
  s_add_u32 s34, s75, 24576
  buffer_load_dwordx4 v2, s[8:11], s34 offen  lds
  s_lshl_b32 s33, s4, 10
  s_add_u32 m0, s33, 98304
  s_add_u32 s34, s75, 32768
  buffer_load_dwordx4 v2, s[8:11], s34 offen  lds
  s_lshl_b32 s33, s4, 10
  s_add_u32 m0, s33, 106496
  s_add_u32 s34, s75, 40960
  buffer_load_dwordx4 v2, s[8:11], s34 offen  lds
  s_lshl_b32 s33, s4, 10
  s_add_u32 m0, s33, 114688
  s_add_u32 s34, s75, 49152
  buffer_load_dwordx4 v2, s[8:11], s34 offen  lds
  s_lshl_b32 s33, s4, 10
  s_add_u32 m0, s33, 122880
  s_add_u32 s34, s75, 57344
  buffer_load_dwordx4 v2, s[8:11], s34 offen  lds
  buffer_load_dwordx4 v[248:251], v13, s[16:19], 0 offen
  s_add_u32 s33, s41, 1
  s_and_b32 s33, s33, 3
  s_lshl_b32 s34, s40, 2
  s_add_u32 s33, s33, s34
  s_mul_i32 s33, s33, 6144
  s_add_u32 s33, s33, 0
  v_add_u32 v5, s33, v2
  ds_write_b128 v5, v[72:75] offset:0
  ds_write_b128 v5, v[88:91] offset:1024
  s_add_u32 s33, s41, 2
  s_and_b32 s33, s33, 3
  s_lshl_b32 s34, s40, 2
  s_add_u32 s33, s33, s34
  s_mul_i32 s33, s33, 6144
  s_add_u32 s33, s33, 2048
  v_add_u32 v5, s33, v2
  ds_write_b128 v5, v[76:79] offset:0
  ds_write_b128 v5, v[92:95] offset:1024
  s_add_u32 s33, s41, 3
  s_and_b32 s33, s33, 3
  s_lshl_b32 s34, s40, 2
  s_add_u32 s33, s33, s34
  s_mul_i32 s33, s33, 6144
  s_add_u32 s33, s33, 4096
  v_add_u32 v5, s33, v2
  ds_write_b128 v5, v[80:83] offset:0
  ds_write_b128 v5, v[96:99] offset:1024
  s_lshl_b32 s34, s40, 2
  s_add_u32 s33, s41, s34
  s_mul_i32 s33, s33, 6144
  v_add_u32 v5, s33, v2
  s_lshl_b32 s33, s40, 15
  s_lshl_b32 s34, s40, 13
  s_add_u32 s33, s33, s34
  s_add_u32 s33, s33, 65536
  v_add_u32 v14, s33, v2
  s_xor_b32 s33, s40, 1
  s_lshl_b32 s33, s33, 15
  s_add_u32 s33, s33, s34
  s_add_u32 s33, s33, 65536
  v_add_u32 v15, s33, v2
  s_lshl_b32 s33, s42, 2
  s_add_u32 s33, s33, s41
  s_lshl_b32 s33, s33, 14
  s_add_u32 s33, s33, s34
  s_add_u32 s35, s33, 15728640
  s_waitcnt lgkmcnt(0)
  s_barrier
  ds_read_b128 v[72:75], v5 offset:0
  ds_read_b128 v[88:91], v5 offset:1024
  ds_read_b128 v[76:79], v5 offset:2048
  ds_read_b128 v[92:95], v5 offset:3072
  ds_read_b128 v[80:83], v5 offset:4096
  ds_read_b128 v[96:99], v5 offset:5120
  s_waitcnt lgkmcnt(0)
  v_pk_add_f32 v[68:69], v[68:69], v[72:73]
  v_pk_add_f32 v[70:71], v[70:71], v[74:75]
  v_pk_add_f32 v[84:85], v[84:85], v[88:89]
  v_pk_add_f32 v[86:87], v[86:87], v[90:91]
  v_pk_add_f32 v[68:69], v[68:69], v[76:77]
  v_pk_add_f32 v[70:71], v[70:71], v[78:79]
  v_pk_add_f32 v[84:85], v[84:85], v[92:93]
  v_pk_add_f32 v[86:87], v[86:87], v[94:95]
  v_pk_add_f32 v[68:69], v[68:69], v[80:81]
  v_pk_add_f32 v[70:71], v[70:71], v[82:83]
  v_pk_add_f32 v[84:85], v[84:85], v[96:97]
  v_pk_add_f32 v[86:87], v[86:87], v[98:99]
  v_mul_f32 v72, 0xbfb8aa3b, v68
  v_mul_f32 v73, 0xbfb8aa3b, v69
  v_mul_f32 v74, 0xbfb8aa3b, v70
  v_mul_f32 v75, 0xbfb8aa3b, v71
  v_mul_f32 v88, 0xbfb8aa3b, v84
  v_mul_f32 v89, 0xbfb8aa3b, v85
  v_mul_f32 v90, 0xbfb8aa3b, v86
  v_mul_f32 v91, 0xbfb8aa3b, v87
  v_exp_f32 v72, v72
  v_exp_f32 v73, v73
  v_exp_f32 v74, v74
  v_exp_f32 v75, v75
  v_exp_f32 v88, v88
  v_exp_f32 v89, v89
  v_exp_f32 v90, v90
  v_exp_f32 v91, v91
  s_nop 0
  v_add_f32 v72, 1.0, v72
  v_add_f32 v73, 1.0, v73
  v_add_f32 v74, 1.0, v74
  v_add_f32 v75, 1.0, v75
  v_add_f32 v88, 1.0, v88
  v_add_f32 v89, 1.0, v89
  v_add_f32 v90, 1.0, v90
  v_add_f32 v91, 1.0, v91
  v_rcp_f32 v72, v72
  v_rcp_f32 v73, v73
  v_rcp_f32 v74, v74
  v_rcp_f32 v75, v75
  v_rcp_f32 v88, v88
  v_rcp_f32 v89, v89
  v_rcp_f32 v90, v90
  v_rcp_f32 v91, v91
  s_nop 0
  v_mul_f32 v240, v72, v68
  v_mul_f32 v241, v73, v69
  v_mul_f32 v242, v74, v70
  v_mul_f32 v243, v75, v71
  v_mul_f32 v244, v88, v84
  v_mul_f32 v245, v89, v85
  v_mul_f32 v246, v90, v86
  v_mul_f32 v247, v91, v87
  s_waitcnt vmcnt(0)
  s_barrier
  v_mov_b32 v6, 0
  buffer_load_dwordx4 v[196:199], v2, s[8:11], s35 offen offset:0 sc1
  buffer_load_dwordx4 v[200:203], v2, s[8:11], s35 offen offset:1024 sc1
  buffer_load_dwordx4 v[204:207], v2, s[8:11], s35 offen offset:2048 sc1
  buffer_load_dwordx4 v[208:211], v2, s[8:11], s35 offen offset:3072 sc1
  s_add_u32 s33, s35, 4096
  buffer_load_dwordx4 v[212:215], v2, s[8:11], s33 offen offset:0 sc1
  buffer_load_dwordx4 v[216:219], v2, s[8:11], s33 offen offset:1024 sc1
  buffer_load_dwordx4 v[220:223], v2, s[8:11], s33 offen offset:2048 sc1
  buffer_load_dwordx4 v[224:227], v2, s[8:11], s33 offen offset:3072 sc1
  ds_read_b128 v[100:103], v14 offset:0
  ds_read_b128 v[132:135], v14 offset:16384
  ds_read_b128 v[164:167], v15 offset:0
  ds_read_b128 v[36:39], v15 offset:16384
  ds_read_b128 v[104:107], v14 offset:1024
  ds_read_b128 v[136:139], v14 offset:17408
  ds_read_b128 v[168:171], v15 offset:1024
  ds_read_b128 v[40:43], v15 offset:17408
  ds_read_b128 v[108:111], v14 offset:2048
  ds_read_b128 v[140:143], v14 offset:18432
  ds_read_b128 v[172:175], v15 offset:2048
  ds_read_b128 v[44:47], v15 offset:18432
  ds_read_b128 v[112:115], v14 offset:3072
  ds_read_b128 v[144:147], v14 offset:19456
  ds_read_b128 v[176:179], v15 offset:3072
  ds_read_b128 v[48:51], v15 offset:19456
  ds_read_b128 v[116:119], v14 offset:4096
  ds_read_b128 v[148:151], v14 offset:20480
  ds_read_b128 v[180:183], v15 offset:4096
  ds_read_b128 v[52:55], v15 offset:20480
  ds_read_b128 v[120:123], v14 offset:5120
  ds_read_b128 v[152:155], v14 offset:21504
  ds_read_b128 v[184:187], v15 offset:5120
  ds_read_b128 v[56:59], v15 offset:21504
  ds_read_b128 v[124:127], v14 offset:6144
  ds_read_b128 v[156:159], v14 offset:22528
  ds_read_b128 v[188:191], v15 offset:6144
  ds_read_b128 v[60:63], v15 offset:22528
  ds_read_b128 v[128:131], v14 offset:7168
  ds_read_b128 v[160:163], v14 offset:23552
  ds_read_b128 v[192:195], v15 offset:7168
  ds_read_b128 v[64:67], v15 offset:23552
  s_mov_b32 s71, 0
  s_waitcnt lgkmcnt(0)
recurrent_scan__grouped_kv_mqa__swiglu_ffn__prompt_kernel_opoll:
  s_waitcnt vmcnt(6)
  v_mfma_f32_16x16x32_bf16 v[68:71], v[100:103], v[196:199], 0
  v_mfma_f32_16x16x32_bf16 v[72:75], v[132:135], v[196:199], 0
  v_mfma_f32_16x16x32_bf16 v[76:79], v[164:167], v[196:199], 0
  v_mfma_f32_16x16x32_bf16 v[80:83], v[36:39], v[196:199], 0
  v_max3_u32 v6, v196, v197, v6
  v_max3_u32 v6, v198, v199, v6
  v_mfma_f32_16x16x32_bf16 v[68:71], v[104:107], v[200:203], v[68:71]
  v_mfma_f32_16x16x32_bf16 v[72:75], v[136:139], v[200:203], v[72:75]
  v_mfma_f32_16x16x32_bf16 v[76:79], v[168:171], v[200:203], v[76:79]
  v_mfma_f32_16x16x32_bf16 v[80:83], v[40:43], v[200:203], v[80:83]
  v_max3_u32 v6, v200, v201, v6
  v_max3_u32 v6, v202, v203, v6
  s_waitcnt vmcnt(4)
  v_mfma_f32_16x16x32_bf16 v[68:71], v[108:111], v[204:207], v[68:71]
  v_mfma_f32_16x16x32_bf16 v[72:75], v[140:143], v[204:207], v[72:75]
  v_mfma_f32_16x16x32_bf16 v[76:79], v[172:175], v[204:207], v[76:79]
  v_mfma_f32_16x16x32_bf16 v[80:83], v[44:47], v[204:207], v[80:83]
  v_max3_u32 v6, v204, v205, v6
  v_max3_u32 v6, v206, v207, v6
  v_mfma_f32_16x16x32_bf16 v[68:71], v[112:115], v[208:211], v[68:71]
  v_mfma_f32_16x16x32_bf16 v[72:75], v[144:147], v[208:211], v[72:75]
  v_mfma_f32_16x16x32_bf16 v[76:79], v[176:179], v[208:211], v[76:79]
  v_mfma_f32_16x16x32_bf16 v[80:83], v[48:51], v[208:211], v[80:83]
  v_max3_u32 v6, v208, v209, v6
  v_max3_u32 v6, v210, v211, v6
  s_waitcnt vmcnt(2)
  v_mfma_f32_16x16x32_bf16 v[68:71], v[116:119], v[212:215], v[68:71]
  v_mfma_f32_16x16x32_bf16 v[72:75], v[148:151], v[212:215], v[72:75]
  v_mfma_f32_16x16x32_bf16 v[76:79], v[180:183], v[212:215], v[76:79]
  v_mfma_f32_16x16x32_bf16 v[80:83], v[52:55], v[212:215], v[80:83]
  v_max3_u32 v6, v212, v213, v6
  v_max3_u32 v6, v214, v215, v6
  v_mfma_f32_16x16x32_bf16 v[68:71], v[120:123], v[216:219], v[68:71]
  v_mfma_f32_16x16x32_bf16 v[72:75], v[152:155], v[216:219], v[72:75]
  v_mfma_f32_16x16x32_bf16 v[76:79], v[184:187], v[216:219], v[76:79]
  v_mfma_f32_16x16x32_bf16 v[80:83], v[56:59], v[216:219], v[80:83]
  v_max3_u32 v6, v216, v217, v6
  v_max3_u32 v6, v218, v219, v6
  s_waitcnt vmcnt(0)
  v_mfma_f32_16x16x32_bf16 v[68:71], v[124:127], v[220:223], v[68:71]
  v_mfma_f32_16x16x32_bf16 v[72:75], v[156:159], v[220:223], v[72:75]
  v_mfma_f32_16x16x32_bf16 v[76:79], v[188:191], v[220:223], v[76:79]
  v_mfma_f32_16x16x32_bf16 v[80:83], v[60:63], v[220:223], v[80:83]
  v_max3_u32 v6, v220, v221, v6
  v_max3_u32 v6, v222, v223, v6
  v_mfma_f32_16x16x32_bf16 v[68:71], v[128:131], v[224:227], v[68:71]
  v_mfma_f32_16x16x32_bf16 v[72:75], v[160:163], v[224:227], v[72:75]
  v_mfma_f32_16x16x32_bf16 v[76:79], v[192:195], v[224:227], v[76:79]
  v_mfma_f32_16x16x32_bf16 v[80:83], v[64:67], v[224:227], v[80:83]
  v_max3_u32 v6, v224, v225, v6
  v_max3_u32 v6, v226, v227, v6
  v_cmp_eq_u32 vcc, -1, v6
  s_add_u32 s71, s71, 1
  s_nop 3
  s_cbranch_vccz recurrent_scan__grouped_kv_mqa__swiglu_ffn__prompt_kernel_ook
  s_cmp_ge_u32 s71, 20000
  s_cbranch_scc1 recurrent_scan__grouped_kv_mqa__swiglu_ffn__prompt_kernel_ook
  s_sleep 1
  v_mov_b32 v6, 0
  buffer_load_dwordx4 v[196:199], v2, s[8:11], s35 offen offset:0 sc1
  buffer_load_dwordx4 v[200:203], v2, s[8:11], s35 offen offset:1024 sc1
  buffer_load_dwordx4 v[204:207], v2, s[8:11], s35 offen offset:2048 sc1
  buffer_load_dwordx4 v[208:211], v2, s[8:11], s35 offen offset:3072 sc1
  s_add_u32 s33, s35, 4096
  buffer_load_dwordx4 v[212:215], v2, s[8:11], s33 offen offset:0 sc1
  buffer_load_dwordx4 v[216:219], v2, s[8:11], s33 offen offset:1024 sc1
  buffer_load_dwordx4 v[220:223], v2, s[8:11], s33 offen offset:2048 sc1
  buffer_load_dwordx4 v[224:227], v2, s[8:11], s33 offen offset:3072 sc1
  s_branch recurrent_scan__grouped_kv_mqa__swiglu_ffn__prompt_kernel_opoll
recurrent_scan__grouped_kv_mqa__swiglu_ffn__prompt_kernel_ook:
  s_lshl_b32 s33, s4, 11
  v_add_u32 v5, s33, v2
  s_xor_b32 s33, s4, 1
  s_lshl_b32 s33, s33, 11
  v_add_u32 v6, s33, v2
  s_nop 2
  ds_write_b128 v5, v[76:79]
  ds_write_b128 v5, v[80:83] offset:1024
  v_lshlrev_b32 v124, 16, v248
  v_and_b32 v125, 0xffff0000, v248
  v_lshlrev_b32 v126, 16, v249
  v_and_b32 v127, 0xffff0000, v249
  v_lshlrev_b32 v128, 16, v250
  v_and_b32 v129, 0xffff0000, v250
  v_lshlrev_b32 v130, 16, v251
  v_and_b32 v131, 0xffff0000, v251
  s_waitcnt lgkmcnt(0)
  s_barrier
  ds_read_b128 v[76:79], v6
  ds_read_b128 v[80:83], v6 offset:1024
  s_waitcnt lgkmcnt(0)
  v_pk_add_f32 v[68:69], v[68:69], v[76:77]
  v_pk_add_f32 v[70:71], v[70:71], v[78:79]
  v_pk_add_f32 v[72:73], v[72:73], v[80:81]
  v_pk_add_f32 v[74:75], v[74:75], v[82:83]
  v_pk_fma_f32 v[124:125], v[68:69], v[240:241], v[124:125]
  v_pk_fma_f32 v[126:127], v[70:71], v[242:243], v[126:127]
  v_pk_fma_f32 v[128:129], v[72:73], v[244:245], v[128:129]
  v_pk_fma_f32 v[130:131], v[74:75], v[246:247], v[130:131]
  v_cvt_pk_bf16_f32 v132, v124, v125
  v_cvt_pk_bf16_f32 v133, v126, v127
  v_cvt_pk_bf16_f32 v134, v128, v129
  v_cvt_pk_bf16_f32 v135, v130, v131
  buffer_store_dwordx4 v[132:135], v13, s[24:27], 0 offen sc1
recurrent_scan__grouped_kv_mqa__swiglu_ffn__prompt_kernel_exit:
  s_endpgm
recurrent_scan__grouped_kv_mqa__swiglu_ffn__prompt_kernel_slow:
  s_waitcnt lgkmcnt(0)
  v_mov_b32 v7, v2
  v_mov_b32 v14, 0xff800000
  s_mov_b32 s72, 0
recurrent_scan__grouped_kv_mqa__swiglu_ffn__prompt_kernel_mx:
  ds_read_b128 v[24:27], v7
  v_add_u32 v7, 1024, v7
  s_waitcnt lgkmcnt(0)
  v_mfma_f32_32x32x16_bf16 v[52:67], v[24:27], v[16:19], 0
  s_nop 7
  s_nop 3
  v_max3_f32 v14, v52, v53, v14
  v_max3_f32 v14, v54, v55, v14
  v_max3_f32 v14, v56, v57, v14
  v_max3_f32 v14, v58, v59, v14
  v_max3_f32 v14, v60, v61, v14
  v_max3_f32 v14, v62, v63, v14
  v_max3_f32 v14, v64, v65, v14
  v_max3_f32 v14, v66, v67, v14
  s_add_u32 s72, s72, 1
  s_cmp_lt_u32 s72, 64
  s_cbranch_scc1 recurrent_scan__grouped_kv_mqa__swiglu_ffn__prompt_kernel_mx
  v_mov_b32 v6, v14
  s_nop 1
  v_permlane32_swap_b32 v6, v14
  v_max_f32 v14, v6, v14
  v_sub_f32 v100, 0, v14
  v_mov_b32 v224, 0
  v_sub_f32 v101, 0, v14
  v_mov_b32 v225, 0
  v_sub_f32 v102, 0, v14
  v_mov_b32 v226, 0
  v_sub_f32 v103, 0, v14
  v_mov_b32 v227, 0
  v_sub_f32 v104, 0, v14
  v_mov_b32 v228, 0
  v_sub_f32 v105, 0, v14
  v_mov_b32 v229, 0
  v_sub_f32 v106, 0, v14
  v_mov_b32 v230, 0
  v_sub_f32 v107, 0, v14
  v_mov_b32 v231, 0
  v_sub_f32 v108, 0, v14
  v_mov_b32 v232, 0
  v_sub_f32 v109, 0, v14
  v_mov_b32 v233, 0
  v_sub_f32 v110, 0, v14
  v_mov_b32 v234, 0
  v_sub_f32 v111, 0, v14
  v_mov_b32 v235, 0
  v_sub_f32 v112, 0, v14
  v_mov_b32 v236, 0
  v_sub_f32 v113, 0, v14
  v_mov_b32 v237, 0
  v_sub_f32 v114, 0, v14
  v_mov_b32 v238, 0
  v_sub_f32 v115, 0, v14
  v_mov_b32 v239, 0
  v_mov_b32 v7, v2
  v_and_b32 v5, 15, v1
  v_lshlrev_b32 v5, 4, v5
  v_lshrrev_b32 v6, 5, v1
  v_lshl_add_u32 v5, v6, 8, v5
  v_add_u32 v8, 65536, v5
  s_mov_b32 s72, 0
recurrent_scan__grouped_kv_mqa__swiglu_ffn__prompt_kernel_ex:
  ds_read_b128 v[24:27], v7
  s_mov_b64 exec, s[36:37]
  ds_read_b128 v[28:31], v8 offset:0
  s_mov_b64 exec, -1
  s_mov_b64 exec, s[36:37]
  ds_read_b128 v[32:35], v8 offset:512
  s_mov_b64 exec, -1
  v_add_u32 v7, 1024, v7
  v_add_u32 v8, 1024, v8
  s_waitcnt lgkmcnt(0)
  v_mfma_f32_32x32x16_bf16 v[52:67], v[24:27], v[16:19], v[100:115]
  s_nop 7
  s_nop 3
  v_exp_f32 v52, v52
  v_exp_f32 v53, v53
  v_exp_f32 v54, v54
  v_exp_f32 v55, v55
  v_exp_f32 v56, v56
  v_exp_f32 v57, v57
  v_exp_f32 v58, v58
  v_exp_f32 v59, v59
  v_exp_f32 v60, v60
  v_exp_f32 v61, v61
  v_exp_f32 v62, v62
  v_exp_f32 v63, v63
  v_exp_f32 v64, v64
  v_exp_f32 v65, v65
  v_exp_f32 v66, v66
  v_exp_f32 v67, v67
  s_nop 1
  v_smfmac_f32_32x32x32_bf16 v[224:239], v[28:31], v[52:59], v10
  v_smfmac_f32_32x32x32_bf16 v[224:239], v[32:35], v[60:67], v10
  s_add_u32 s72, s72, 1
  s_cmp_lt_u32 s72, 64
  s_cbranch_scc1 recurrent_scan__grouped_kv_mqa__swiglu_ffn__prompt_kernel_ex
  s_nop 7
  s_nop 3
  s_barrier
  s_branch recurrent_scan__grouped_kv_mqa__swiglu_ffn__prompt_kernel_ost
recurrent_scan__grouped_kv_mqa__swiglu_ffn__prompt_kernel_end:
.section .rodata,"a"
.p2align 6
.amdhsa_kernel recurrent_scan__grouped_kv_mqa__swiglu_ffn__prompt_kernel
  .amdhsa_next_free_vgpr 256
  .amdhsa_next_free_sgpr 96
  .amdhsa_accum_offset 256
  .amdhsa_group_segment_fixed_size 0
  .amdhsa_kernarg_size 96
  .amdhsa_user_sgpr_count 2
  .amdhsa_user_sgpr_kernarg_segment_ptr 1
  .amdhsa_system_sgpr_workgroup_id_x 1
.end_amdhsa_kernel
```
